```python
import torch

def _softmax(x, axis=-1):
    return torch.softmax(x, dim=axis)
def _gelu(x):
    return torch.nn.functional.gelu(x, approximate="tanh")
def _silu(x):
    return torch.nn.functional.silu(x)
def _sigmoid(x):
    return torch.sigmoid(x)
def _layernorm(x, axis=-1, eps=1e-5):
    m = x.mean(dim=axis, keepdim=True)
    v = x.var(dim=axis, keepdim=True, unbiased=False)
    return (x - m) / torch.sqrt(v + eps)
def _scatter_add(tgt, idx, src, axis=0):
    return tgt.clone().index_add_(axis, idx, src)
def _segment_sum(src, seg, n):
    out = torch.zeros((n,) + src.shape[1:], dtype=src.dtype)
    return out.index_add_(0, seg, src)
def _pad(x, pw):
    flat = tuple(v for pair in reversed(pw) for v in pair)
    return torch.nn.functional.pad(x, flat)

kernel_name = 'gated_mix__compressed_kv_cla__mixer_token_mlp__decode'

def setup_inputs():

    _w = (lambda a: (lambda t: t.to(torch.bfloat16) if t.is_floating_point() else t)(torch.as_tensor(a)))
    def _A_setup():
        B, H, Sq, Sk, D, M = 4, 32, 1, 4096, 128, 576
        Dc = 4 * D
        return {
            "x": _w((lambda *s: torch.randn(*s, dtype=torch.bfloat16) * 0.05)(B, Sq, M)),
            "c_kv": _w((lambda *s: torch.randn(*s, dtype=torch.bfloat16) * 0.4)(B, Sk, Dc)),
            "w_q": _w((lambda *s: torch.randn(*s, dtype=torch.bfloat16) * 3.2)(M, H, D) * (M ** -0.5)),
            "w_uk": _w((lambda *s: torch.randn(*s, dtype=torch.bfloat16) * 3.2)(Dc, H, D) * (Dc ** -0.5)),
            "w_uv": _w((lambda *s: torch.randn(*s, dtype=torch.bfloat16) * 0.4)(Dc, H, D) * (Dc ** -0.5)),
            "w_o": _w((lambda *s: torch.randn(*s, dtype=torch.bfloat16) * 0.4)(H, D, M) * ((H * D) ** -0.5)),
        }
    _A_in = _A_setup()

    def _B_setup():
        B, S, D, F = 4, 1, 576, 4608
        return {
            "x": _w((lambda *s: torch.randn(*s, dtype=torch.bfloat16) * 0.05)(B, S, D)),
            "w1": _w((lambda *s: torch.randn(*s, dtype=torch.bfloat16) * 0.05)(S, F) * (S ** -0.5)),
            "b1": _w((lambda *s: torch.randn(*s, dtype=torch.bfloat16) * 0.05)(F) * 0.02),
            "w2": _w((lambda *s: torch.randn(*s, dtype=torch.bfloat16) * 0.05)(F, S) * (F ** -0.5)),
            "b2": _w((lambda *s: torch.randn(*s, dtype=torch.bfloat16) * 0.05)(S) * 0.02),
        }
    _B_in = _B_setup()

    return {
        "A_x": _A_in["x"],
        "A_c_kv": _A_in["c_kv"],
        "A_w_q": _A_in["w_q"],
        "A_w_uk": _A_in["w_uk"],
        "A_w_uv": _A_in["w_uv"],
        "A_w_o": _A_in["w_o"],
        "B_x": _B_in["x"],
        "B_w1": _B_in["w1"],
        "B_b1": _B_in["b1"],
        "B_w2": _B_in["w2"],
        "B_b2": _B_in["b2"],
        "gate_w": _w((lambda *s: torch.randn(*s, dtype=torch.bfloat16) * 0.05)(576) * 16.0),
    }

def reference(A_x, A_c_kv, A_w_q, A_w_uk, A_w_uv, A_w_o, B_x, B_w1, B_b1, B_w2, B_b2, gate_w):
    def _A_ref(x, c_kv, w_q, w_uk, w_uv, w_o):
        B, Sq, M = x.shape[0], x.shape[1], x.shape[2]
        Sk = c_kv.shape[1]
        H, D = w_q.shape[1], w_q.shape[2]
        q = torch.einsum("bqm,mhd->bhqd", x, w_q)
        k = torch.einsum("bkc,chd->bhkd", c_kv, w_uk)
        v = torch.einsum("bkc,chd->bhkd", c_kv, w_uv)
        scores = torch.einsum("bhqd,bhkd->bhqk", q, k) * (D ** -0.5)
        off = Sk - Sq
        qi = torch.arange(Sq)[:, None]
        kj = torch.arange(Sk)[None, :]
        cmask = kj <= (qi + off)
        scores = torch.where(cmask[None, None], scores, -1e9)
        p = _softmax(scores, axis=-1)
        ctx = torch.einsum("bhqk,bhkd->bhqd", p, v)
        return torch.einsum("bhqd,hdm->bqm", ctx, w_o)

    def _B_ref(x, w1, b1, w2, b2):
        B, S, D = x.shape
        h = _layernorm(x, axis=-1)
        u = torch.einsum("bsd,sf->bdf", h, w1) + b1
        u = _gelu(u)
        y = torch.einsum("bdf,fs->bds", u, w2) + b2
        return (lambda x, *d: x.permute(*d))(y, 0, 2, 1)

    x = A_x
    g = _sigmoid((x * gate_w).sum(-1, keepdims=True))
    a = _A_ref(x, A_c_kv, A_w_q, A_w_uk, A_w_uv, A_w_o)
    b = _B_ref(x, B_w1, B_b1, B_w2, B_b2)
    return g * a + (1 - g) * b
```

```asm
; @launch grid=(256,1,1) block=(512,1,1) lds=163840
.amdgcn_target "amdgcn-amd-amdhsa--gfx950"
.text
.globl gated_mix__compressed_kv_cla__mixer_token_mlp__decode_kernel
.p2align 8
.type gated_mix__compressed_kv_cla__mixer_token_mlp__decode_kernel,@function
gated_mix__compressed_kv_cla__mixer_token_mlp__decode_kernel:
    s_cmp_ge_u32 s2, 256
    s_cbranch_scc1 L_end
    s_load_dwordx16 s[8:23], s[0:1], 0
    s_load_dwordx8 s[24:31], s[0:1], 64
    s_load_dwordx4 s[32:35], s[0:1], 96
    s_load_dwordx2 s[36:37], s[0:1], 112
    s_getpc_b64 s[58:59]
L_pc:
    s_lshr_b32 s3, s2, 3
    s_and_b32 s3, s3, 15
    s_lshl_b32 s3, s3, 11
    v_lshl_add_u32 v255, v0, 6, s3
    v_min_u32 v255, L_end-L_pc, v255
    v_cmp_gt_u32 vcc, 32, v0
    s_nop 0
    s_and_saveexec_b64 s[56:57], vcc
    s_cbranch_execz L_nopf
    global_load_dword v254, v255, s[58:59]
L_nopf:
    s_mov_b64 exec, s[56:57]
    v_and_b32 v1, 63, v0
    v_lshrrev_b32 v2, 6, v0
    s_nop 0
    v_readfirstlane_b32 s39, v2
    v_and_b32 v2, 15, v1
    v_lshrrev_b32 v3, 4, v1
    s_and_b32 s72, s2, 127
    s_cmp_lt_u32 s2, 128
    s_cbranch_scc0 L_C
    s_and_b32 s56, s72, 7
    s_lshl_b32 s56, s56, 2
    s_lshr_b32 s57, s72, 5
    s_add_u32 s56, s56, s57
    s_lshr_b32 s57, s72, 3
    s_and_b32 s57, s57, 3
    s_mul_i32 s58, s39, 20
    s_lshl_b32 s59, s39, 4
    s_add_u32 s59, s59, 16
    s_cmp_lt_u32 s39, 4
    s_cselect_b32 s73, 5, 4
    s_cselect_b32 s58, s58, s59
    s_mul_i32 s59, s57, 144
    s_add_u32 s58, s58, s59
    s_lshl_b32 s3, s73, 13
    v_mul_u32_u24 v5, s3, v3
    v_lshl_add_u32 v5, v2, 4, v5
    v_mul_u32_u24 v4, s73, v3
    v_add_u32 v4, s58, v4
    v_and_b32 v6, 3, v2
    s_movk_i32 s3, 576
    v_mad_u32_u24 v4, v6, s3, v4
    v_lshlrev_b32 v4, 1, v4
    v_and_b32 v10, 2, v4
    v_and_b32 v4, -4, v4
    s_lshl_b32 s58, s58, 13
    s_lshl_b32 s3, s56, 8
    s_add_u32 s58, s58, s3
    s_waitcnt lgkmcnt(0)
    s_mov_b32 s44, s8
    s_and_b32 s45, s9, 0xffff
    s_mov_b32 s46, 4608
    s_mov_b32 s47, 0x20000
    buffer_load_dwordx4 v[36:39], v4, s[44:47], 0 offen
    s_mov_b32 s40, s12
    s_and_b32 s41, s13, 0xffff
    s_mov_b32 s42, 4718592
    s_mov_b32 s43, 0x20000
    buffer_load_dwordx4 v[16:19], v5, s[40:43], s58 offen nt
    s_add_u32 s58, s58, 8192
    buffer_load_dwordx4 v[20:23], v5, s[40:43], s58 offen nt
    s_add_u32 s58, s58, 8192
    buffer_load_dwordx4 v[24:27], v5, s[40:43], s58 offen nt
    s_add_u32 s58, s58, 8192
    buffer_load_dwordx4 v[28:31], v5, s[40:43], s58 offen nt
    s_add_u32 s58, s58, 8192
    s_cmp_lt_u32 s39, 4
    s_cbranch_scc0 L_W_skip5
    buffer_load_dwordx4 v[32:35], v5, s[40:43], s58 offen nt
    s_branch L_W_skip5b
L_W_skip5:
    v_mov_b32 v32, 0
    v_mov_b32 v33, 0
    v_mov_b32 v34, 0
    v_mov_b32 v35, 0
L_W_skip5b:
    s_mov_b32 s48, s14
    s_and_b32 s49, s15, 0xffff
    s_mov_b32 s50, 4194304
    s_mov_b32 s51, 0x20000
    s_lshl_b32 s34, s57, 7
    s_lshl_b32 s35, s39, 4
    s_add_u32 s34, s34, s35
    s_lshl_b32 s34, s34, 13
    s_lshl_b32 s3, s56, 8
    s_add_u32 s76, s34, s3
    s_lshl_b32 s78, s39, 12
    v_lshlrev_b32 v6, 13, v3
    v_add_u32 v7, 0, v3
    v_xor_b32 v7, v7, v2
    v_lshl_add_u32 v40, v7, 4, v6
    v_add_u32 v7, 4, v3
    v_xor_b32 v7, v7, v2
    v_lshl_add_u32 v41, v7, 4, v6
    v_add_u32 v7, 8, v3
    v_xor_b32 v7, v7, v2
    v_lshl_add_u32 v42, v7, 4, v6
    v_add_u32 v7, 12, v3
    v_xor_b32 v7, v7, v2
    v_lshl_add_u32 v43, v7, 4, v6
    s_barrier
    s_add_u32 m0, s78, 0
    s_nop 0
    buffer_load_dwordx4 v40, s[48:51], s76 offen nt lds
    s_add_u32 m0, s78, 1024
    s_add_u32 s3, s76, 32768
    buffer_load_dwordx4 v41, s[48:51], s3 offen nt lds
    s_add_u32 m0, s78, 2048
    s_add_u32 s3, s76, 65536
    buffer_load_dwordx4 v42, s[48:51], s3 offen nt lds
    s_add_u32 m0, s78, 3072
    s_add_u32 s3, s76, 98304
    buffer_load_dwordx4 v43, s[48:51], s3 offen nt lds
    s_load_dword s38, s[36:37], 0
    s_mov_b32 s4, s36
    s_and_b32 s5, s37, 0xffff
    s_mov_b32 s6, 268435456
    s_mov_b32 s7, 0x20000
    v_mov_b32 v8, 0x5040100
    v_mov_b32 v9, 0x7060302
    v_mov_b32 v99, 0
    v_mov_b32 v103, 0
    v_mov_b32 v107, 0
    v_mov_b32 v111, 0
    v_mov_b32 v115, 0
    v_mov_b32 v119, 0
    v_mov_b32 v123, 0
    v_mov_b32 v127, 0
    v_mov_b32 v51, 0
    v_mov_b32 v55, 0
    v_mov_b32 v59, 0
    v_mov_b32 v63, 0
    v_mov_b32 v6, 147456
    v_mov_b32 v7, 0
    ds_write_b32 v6, v7
    v_lshrrev_b32 v6, 2, v2
    s_lshl_b32 s58, s39, 11
    v_lshl_add_u32 v11, v1, 4, s58
    s_cmp_lt_u32 s39, 4
    s_cselect_b32 s3, 0xffff, 0
    s_cbranch_scc1 L_W_xw5
    s_waitcnt vmcnt(8)
    s_branch L_W_xw
L_W_xw5:
    s_waitcnt vmcnt(9)
L_W_xw:
    v_alignbyte_b32 v44, v37, v36, v10
    v_alignbyte_b32 v45, v38, v37, v10
    v_alignbyte_b32 v46, v39, v38, v10
    v_and_b32 v46, s3, v46
    v_cmp_eq_u32 vcc, 0, v6
    s_nop 1
    v_cndmask_b32 v48, 0, v44, vcc
    v_cndmask_b32 v49, 0, v45, vcc
    v_cndmask_b32 v50, 0, v46, vcc
    v_cmp_eq_u32 vcc, 1, v6
    s_nop 1
    v_cndmask_b32 v52, 0, v44, vcc
    v_cndmask_b32 v53, 0, v45, vcc
    v_cndmask_b32 v54, 0, v46, vcc
    v_cmp_eq_u32 vcc, 2, v6
    s_nop 1
    v_cndmask_b32 v56, 0, v44, vcc
    v_cndmask_b32 v57, 0, v45, vcc
    v_cndmask_b32 v58, 0, v46, vcc
    v_cmp_eq_u32 vcc, 3, v6
    s_nop 1
    v_cndmask_b32 v60, 0, v44, vcc
    v_cndmask_b32 v61, 0, v45, vcc
    v_cndmask_b32 v62, 0, v46, vcc
    s_waitcnt lgkmcnt(0)
    s_add_u32 s38, s38, 1
    s_and_b32 s60, s38, 0xff
    s_bfe_u32 s61, s38, 0x80008
    s_bfe_u32 s62, s38, 0x80010
    s_lshr_b32 s63, s38, 24
    s_waitcnt vmcnt(4)
    v_perm_b32 v96, v20, v16, v8
    v_perm_b32 v97, v28, v24, v8
    v_and_b32 v98, 0xffff, v32
    v_perm_b32 v100, v20, v16, v9
    v_perm_b32 v101, v28, v24, v9
    v_lshrrev_b32 v102, 16, v32
    v_perm_b32 v104, v21, v17, v8
    v_perm_b32 v105, v29, v25, v8
    v_and_b32 v106, 0xffff, v33
    v_perm_b32 v108, v21, v17, v9
    v_perm_b32 v109, v29, v25, v9
    v_lshrrev_b32 v110, 16, v33
    v_perm_b32 v112, v22, v18, v8
    v_perm_b32 v113, v30, v26, v8
    v_and_b32 v114, 0xffff, v34
    v_perm_b32 v116, v22, v18, v9
    v_perm_b32 v117, v30, v26, v9
    v_lshrrev_b32 v118, 16, v34
    v_perm_b32 v120, v23, v19, v8
    v_perm_b32 v121, v31, v27, v8
    v_and_b32 v122, 0xffff, v35
    v_perm_b32 v124, v23, v19, v9
    v_perm_b32 v125, v31, v27, v9
    v_lshrrev_b32 v126, 16, v35
    v_mfma_f32_16x16x32_bf16 v[64:67], v[48:51], v[96:99], 0
    v_mfma_f32_16x16x32_bf16 v[68:71], v[48:51], v[112:115], 0
    v_mfma_f32_16x16x32_bf16 v[64:67], v[52:55], v[100:103], v[64:67]
    v_mfma_f32_16x16x32_bf16 v[68:71], v[52:55], v[116:119], v[68:71]
    v_mfma_f32_16x16x32_bf16 v[64:67], v[56:59], v[104:107], v[64:67]
    v_mfma_f32_16x16x32_bf16 v[68:71], v[56:59], v[120:123], v[68:71]
    v_mfma_f32_16x16x32_bf16 v[64:67], v[60:63], v[108:111], v[64:67]
    v_mfma_f32_16x16x32_bf16 v[68:71], v[60:63], v[124:127], v[68:71]
    s_nop 6
    ds_write_b128 v11, v[64:67] offset:32768
    ds_write_b128 v11, v[68:71] offset:33792
    s_waitcnt lgkmcnt(0)
    s_barrier
    s_cmp_lt_u32 s39, 2
    s_cbranch_scc1 L_W_e1
    s_cmp_lt_u32 s39, 4
    s_cbranch_scc1 L_W_e1p
    s_lshr_b32 s74, s72, 5
    s_and_b32 s75, s72, 31
    s_mul_i32 s75, s75, 18
    s_add_u32 s75, s75, 9
    s_mov_b32 s71, 9
    s_sub_u32 s77, s39, 4
    s_mov_b32 s40, s22
    s_and_b32 s41, s23, 0xffff
    s_mov_b32 s42, 9216
    s_mov_b32 s43, 0x20000
    s_mov_b32 s44, s24
    s_and_b32 s45, s25, 0xffff
    s_mov_b32 s46, 9216
    s_mov_b32 s47, 0x20000
    s_mov_b32 s48, s26
    s_and_b32 s49, s27, 0xffff
    s_mov_b32 s50, 9216
    s_mov_b32 s51, 0x20000
    s_mov_b32 s52, s8
    s_and_b32 s53, s9, 0xffff
    s_mov_b32 s54, 4608
    s_mov_b32 s55, 0x20000
    s_mul_i32 s3, s74, 1152
    v_lshlrev_b32 v4, 4, v1
    v_lshlrev_b32 v5, 2, v1
    buffer_load_dwordx4 v[222:225], v4, s[52:55], s3 offen
    buffer_load_dword v226, v5, s[52:55], s3 offen offset:1024
    s_lshl_b32 s34, s75, 1
    s_add_u32 s34, s34, s3
    v_lshlrev_b32 v6, 1, v1
    buffer_load_ushort v227, v6, s[52:55], s34 offen
    s_mul_i32 s34, s77, 2304
    buffer_load_dwordx4 v[192:195], v4, s[40:43], s34 offen
    buffer_load_dwordx4 v[196:199], v4, s[40:43], s34 offen offset:1024
    buffer_load_dword v200, v5, s[40:43], s34 offen offset:2048
    buffer_load_dwordx4 v[202:205], v4, s[44:47], s34 offen
    buffer_load_dwordx4 v[206:209], v4, s[44:47], s34 offen offset:1024
    buffer_load_dword v210, v5, s[44:47], s34 offen offset:2048
    buffer_load_dwordx4 v[212:215], v4, s[48:51], s34 offen
    buffer_load_dwordx4 v[216:219], v4, s[48:51], s34 offen offset:1024
    buffer_load_dword v220, v5, s[48:51], s34 offen offset:2048
    s_mov_b32 s79, 1
    s_branch L_MLP
L_W_prepret:
    s_branch L_W_e1done2
L_W_e1:
    v_lshlrev_b32 v10, 4, v0
    ds_read_b128 v[64:67], v10 offset:32768
    ds_read_b128 v[68:71], v10 offset:34816
    ds_read_b128 v[72:75], v10 offset:36864
    ds_read_b128 v[76:79], v10 offset:38912
    ds_read_b128 v[80:83], v10 offset:40960
    ds_read_b128 v[84:87], v10 offset:43008
    ds_read_b128 v[88:91], v10 offset:45056
    ds_read_b128 v[92:95], v10 offset:47104
    v_mov_b32 v11, 0xff
    s_lshl_b32 s34, s56, 13
    s_lshl_b32 s35, s57, 11
    s_add_u32 s35, s35, s34
    s_add_u32 s35, s35, 131072
    s_waitcnt lgkmcnt(0)
    v_pk_add_f32 v[64:65], v[64:65], v[80:81]
    v_pk_add_f32 v[66:67], v[66:67], v[82:83]
    v_pk_add_f32 v[68:69], v[68:69], v[84:85]
    v_pk_add_f32 v[70:71], v[70:71], v[86:87]
    v_pk_add_f32 v[72:73], v[72:73], v[88:89]
    v_pk_add_f32 v[74:75], v[74:75], v[90:91]
    v_pk_add_f32 v[76:77], v[76:77], v[92:93]
    v_pk_add_f32 v[78:79], v[78:79], v[94:95]
    v_pk_add_f32 v[64:65], v[64:65], v[72:73]
    v_pk_add_f32 v[66:67], v[66:67], v[74:75]
    v_pk_add_f32 v[68:69], v[68:69], v[76:77]
    v_pk_add_f32 v[70:71], v[70:71], v[78:79]
    v_pk_add_f32 v[64:65], v[64:65], v[68:69]
    v_pk_add_f32 v[66:67], v[66:67], v[70:71]
    v_bfi_b32 v64, v11, s60, v64
    v_bfi_b32 v65, v11, s61, v65
    v_bfi_b32 v66, v11, s62, v66
    v_bfi_b32 v67, v11, s63, v67
    buffer_store_dwordx4 v[64:67], v10, s[4:7], s35 offen sc1
    s_waitcnt vmcnt(1)
    s_branch L_W_e1done3
L_W_e1p:
    v_subrev_u32 v18, 128, v0
    v_lshlrev_b32 v10, 4, v18
    v_mov_b32 v12, 0x0c0c0400
    s_lshl_b32 s34, s56, 13
    s_add_u32 s34, s34, 131072
    v_and_b32 v13, 15, v18
    v_lshlrev_b32 v13, 3, v13
    v_lshrrev_b32 v14, 6, v18
    v_lshl_add_u32 v13, v14, 2, v13
    v_bfe_u32 v14, v18, 4, 2
    v_add_u32 v13, v13, v14
    v_lshlrev_b32 v15, 1, v13
    s_mov_b32 s59, 0
    s_add_u32 s35, s34, 4096
    v_and_b32 v16, 3, v1
    v_lshlrev_b32 v16, 12, v16
    s_lshl_b32 s58, s56, 7
    s_add_u32 s58, s58, 65536
L_W_e1poll:
    buffer_load_dwordx4 v[68:71], v10, s[4:7], s34 offen offset:0 sc1
    buffer_load_dwordx4 v[72:75], v10, s[4:7], s34 offen offset:2048 sc1
    buffer_load_dwordx4 v[76:79], v10, s[4:7], s35 offen offset:0 sc1
    buffer_load_dwordx4 v[80:83], v10, s[4:7], s35 offen offset:2048 sc1
    buffer_load_dword v17, v16, s[4:7], s58 offen sc1
    s_add_u32 s59, s59, 1
    s_waitcnt vmcnt(0)
    v_xor_b32 v68, s60, v68
    v_xor_b32 v69, s61, v69
    v_xor_b32 v70, s62, v70
    v_xor_b32 v71, s63, v71
    v_or3_b32 v13, v68, v69, v70
    v_or_b32 v13, v13, v71
    v_xor_b32 v72, s60, v72
    v_xor_b32 v73, s61, v73
    v_xor_b32 v74, s62, v74
    v_xor_b32 v75, s63, v75
    v_or3_b32 v13, v13, v72, v73
    v_or3_b32 v13, v13, v74, v75
    v_xor_b32 v76, s60, v76
    v_xor_b32 v77, s61, v77
    v_xor_b32 v78, s62, v78
    v_xor_b32 v79, s63, v79
    v_or3_b32 v13, v13, v76, v77
    v_or3_b32 v13, v13, v78, v79
    v_xor_b32 v80, s60, v80
    v_xor_b32 v81, s61, v81
    v_xor_b32 v82, s62, v82
    v_xor_b32 v83, s63, v83
    v_or3_b32 v13, v13, v80, v81
    v_or3_b32 v13, v13, v82, v83
    v_and_b32 v13, 0xff, v13
    v_cmp_eq_u32 vcc, 0, v13
    v_cmp_eq_u32 s[20:21], s38, v17
    s_nop 0
    s_and_b64 vcc, vcc, s[20:21]
    s_cmp_eq_u64 vcc, -1
    s_cbranch_scc1 L_W_e1ok
    s_cmp_lt_u32 s59, 40000
    s_cbranch_scc1 L_W_e1poll
L_W_e1ok:
    v_pk_add_f32 v[68:69], v[68:69], v[72:73]
    v_pk_add_f32 v[70:71], v[70:71], v[74:75]
    v_pk_add_f32 v[76:77], v[76:77], v[80:81]
    v_pk_add_f32 v[78:79], v[78:79], v[82:83]
    v_pk_add_f32 v[68:69], v[68:69], v[76:77]
    v_pk_add_f32 v[70:71], v[70:71], v[78:79]
    v_cvt_pk_bf16_f32 v68, v68, v69
    v_cvt_pk_bf16_f32 v70, v70, v71
    ds_write_b16 v15, v68 offset:49152
    ds_write_b16_d16_hi v15, v68 offset:49408
    ds_write_b16 v15, v70 offset:49664
    ds_write_b16_d16_hi v15, v70 offset:49920
L_W_e1done2:
    s_waitcnt vmcnt(0)
L_W_e1done3:
    v_xor_b32 v10, v3, v2
    v_lshlrev_b32 v10, 4, v10
    v_lshlrev_b32 v11, 8, v2
    s_lshl_b32 s3, s39, 12
    v_add_u32 v11, s3, v11
    v_and_b32 v12, 3, v2
    v_lshlrev_b32 v12, 8, v12
    v_lshl_add_u32 v12, v3, 4, v12
    v_xor_b32 v76, 0, v10
    v_add_u32 v76, v76, v11
    v_xor_b32 v77, 64, v10
    v_add_u32 v77, v77, v11
    v_xor_b32 v78, 128, v10
    v_add_u32 v78, v78, v11
    v_xor_b32 v79, 192, v10
    v_add_u32 v79, v79, v11
    ds_read_b128 v[16:19], v76 offset:0
    ds_read_b128 v[20:23], v77 offset:0
    ds_read_b128 v[24:27], v78 offset:0
    ds_read_b128 v[28:31], v79 offset:0
    v_lshlrev_b32 v13, 15, v2
    v_lshl_add_u32 v13, v3, 3, v13
    s_lshl_b32 s34, s56, 10
    s_lshl_b32 s35, s57, 8
    s_add_u32 s34, s34, s35
    s_lshl_b32 s35, s39, 5
    s_add_u32 s34, s34, s35
    s_add_u32 s34, s34, 524288
    s_mov_b32 s3, 0x3e0293ee
    s_mov_b32 s20, 0x000f000f
    s_mov_b32 s21, 0x000f000f
    s_waitcnt lgkmcnt(0)
    s_barrier
    ds_read_b128 v[32:35], v12 offset:49152
    ds_read_b128 v[36:39], v12 offset:49216
    ds_read_b128 v[40:43], v12 offset:49280
    ds_read_b128 v[44:47], v12 offset:49344
    s_waitcnt lgkmcnt(3)
    v_mfma_f32_16x16x32_bf16 v[64:67], v[16:19], v[32:35], 0
    s_waitcnt lgkmcnt(2)
    v_mfma_f32_16x16x32_bf16 v[64:67], v[20:23], v[36:39], v[64:67]
    s_waitcnt lgkmcnt(1)
    v_mfma_f32_16x16x32_bf16 v[64:67], v[24:27], v[40:43], v[64:67]
    s_waitcnt lgkmcnt(0)
    v_mfma_f32_16x16x32_bf16 v[64:67], v[28:31], v[44:47], v[64:67]
    s_nop 7
    v_cvt_pk_bf16_f32 v64, v64, v65
    v_cvt_pk_bf16_f32 v65, v66, v67
    s_mov_b64 exec, s[20:21]
    buffer_store_dwordx2 v[64:65], v13, s[4:7], s34 offen sc1
    s_mov_b64 exec, -1
    s_barrier
    s_cmp_lt_u32 s39, 4
    s_cbranch_scc1 L_W_late
    s_mov_b32 s79, 2
    s_branch L_MLP_go
L_W_late:
    s_mov_b32 s40, s16
    s_and_b32 s41, s17, 0xffff
    s_mov_b32 s42, 4194304
    s_mov_b32 s43, 0x20000
    s_mov_b32 s44, s18
    s_and_b32 s45, s19, 0xffff
    s_mov_b32 s46, 4718592
    s_mov_b32 s47, 0x20000
    v_lshlrev_b32 v5, 16, v3
    v_lshl_add_u32 v5, v2, 4, v5
    s_lshl_b32 s34, s57, 7
    s_lshl_b32 s35, s39, 5
    s_add_u32 s34, s34, s35
    s_lshl_b32 s34, s34, 13
    s_lshl_b32 s3, s56, 8
    s_add_u32 s76, s34, s3
    s_movk_i32 s3, 1821
    v_add_u32 v6, 0, v1
    v_mul_u32_u24 v6, s3, v6
    v_lshrrev_b32 v6, 18, v6
    v_lshlrev_b32 v6, 1, v6
    v_xor_b32 v6, v6, v1
    v_lshlrev_b32 v50, 4, v6
    v_add_u32 v6, 64, v1
    v_mul_u32_u24 v6, s3, v6
    v_lshrrev_b32 v6, 18, v6
    v_lshlrev_b32 v6, 1, v6
    v_xor_b32 v6, v6, v1
    v_lshlrev_b32 v51, 4, v6
    v_add_u32 v6, 128, v1
    v_mul_u32_u24 v6, s3, v6
    v_lshrrev_b32 v6, 18, v6
    v_lshlrev_b32 v6, 1, v6
    v_xor_b32 v6, v6, v1
    v_lshlrev_b32 v52, 4, v6
    v_add_u32 v6, 192, v1
    v_mul_u32_u24 v6, s3, v6
    v_lshrrev_b32 v6, 18, v6
    v_lshlrev_b32 v6, 1, v6
    v_xor_b32 v6, v6, v1
    v_lshlrev_b32 v53, 4, v6
    v_add_u32 v6, 256, v1
    v_mul_u32_u24 v6, s3, v6
    v_lshrrev_b32 v6, 18, v6
    v_lshlrev_b32 v6, 1, v6
    v_xor_b32 v6, v6, v1
    v_lshlrev_b32 v54, 4, v6
    v_add_u32 v6, 320, v1
    v_mul_u32_u24 v6, s3, v6
    v_lshrrev_b32 v6, 18, v6
    v_lshlrev_b32 v6, 1, v6
    v_xor_b32 v6, v6, v1
    v_lshlrev_b32 v55, 4, v6
    v_add_u32 v6, 384, v1
    v_mul_u32_u24 v6, s3, v6
    v_lshrrev_b32 v6, 18, v6
    v_lshlrev_b32 v6, 1, v6
    v_xor_b32 v6, v6, v1
    v_lshlrev_b32 v56, 4, v6
    v_add_u32 v6, 448, v1
    v_mul_u32_u24 v6, s3, v6
    v_lshrrev_b32 v6, 18, v6
    v_lshlrev_b32 v6, 1, v6
    v_xor_b32 v6, v6, v1
    v_lshlrev_b32 v57, 4, v6
    v_add_u32 v6, 512, v1
    v_mul_u32_u24 v6, s3, v6
    v_lshrrev_b32 v6, 18, v6
    v_lshlrev_b32 v6, 1, v6
    v_xor_b32 v6, v6, v1
    v_lshlrev_b32 v58, 4, v6
    s_lshl_b32 s35, s57, 2
    s_add_u32 s35, s35, s39
    s_mul_i32 s35, s35, 9216
    s_mul_i32 s78, s56, 147456
    v_lshlrev_b32 v4, 4, v1
    v_add_u32 v4, s72, v4
    v_and_b32 v4, 127, v4
    v_lshlrev_b32 v4, 7, v4
    s_mov_b32 s58, 114688
    s_mov_b32 s59, 0
L_W_gop:
    s_mov_b64 exec, 0xff
    buffer_load_dword v6, v4, s[4:7], s58 offen sc1
    s_add_u32 s59, s59, 1
    s_waitcnt vmcnt(0)
    v_cmp_eq_u32 vcc, s38, v6
    s_mov_b64 exec, -1
    s_and_b32 s3, vcc_lo, 0xff
    s_bcnt1_i32_b32 s3, s3
    s_cmp_ge_u32 s3, 4
    s_cbranch_scc1 L_W_gook
    s_sleep 2
    s_cmp_lt_u32 s59, 40000
    s_cbranch_scc1 L_W_gop
L_W_gook:
    buffer_load_dwordx4 v[16:19], v5, s[40:43], s76 offen nt
    s_add_u32 s76, s76, 8192
    buffer_load_dwordx4 v[20:23], v5, s[40:43], s76 offen nt
    s_add_u32 s76, s76, 8192
    buffer_load_dwordx4 v[24:27], v5, s[40:43], s76 offen nt
    s_add_u32 s76, s76, 8192
    buffer_load_dwordx4 v[28:31], v5, s[40:43], s76 offen nt
    s_add_u32 s76, s76, 8192
    buffer_load_dwordx4 v[32:35], v5, s[40:43], s76 offen nt
    s_add_u32 s76, s76, 8192
    buffer_load_dwordx4 v[36:39], v5, s[40:43], s76 offen nt
    s_add_u32 s76, s76, 8192
    buffer_load_dwordx4 v[40:43], v5, s[40:43], s76 offen nt
    s_add_u32 s76, s76, 8192
    buffer_load_dwordx4 v[44:47], v5, s[40:43], s76 offen nt
    s_mov_b32 s76, 0
L_W_wo:
    s_add_u32 s34, s78, s35
    s_add_u32 m0, s35, 0
    s_nop 0
    buffer_load_dwordx4 v50, s[44:47], s34 offen lds
    s_add_u32 m0, s35, 1024
    s_add_u32 s3, s34, 1024
    buffer_load_dwordx4 v51, s[44:47], s3 offen lds
    s_add_u32 m0, s35, 2048
    s_add_u32 s3, s34, 2048
    buffer_load_dwordx4 v52, s[44:47], s3 offen lds
    s_add_u32 m0, s35, 3072
    s_add_u32 s3, s34, 3072
    buffer_load_dwordx4 v53, s[44:47], s3 offen lds
    s_add_u32 m0, s35, 4096
    s_add_u32 s3, s34, 4096
    buffer_load_dwordx4 v54, s[44:47], s3 offen lds
    s_add_u32 m0, s35, 5120
    s_add_u32 s3, s34, 5120
    buffer_load_dwordx4 v55, s[44:47], s3 offen lds
    s_add_u32 m0, s35, 6144
    s_add_u32 s3, s34, 6144
    buffer_load_dwordx4 v56, s[44:47], s3 offen lds
    s_add_u32 m0, s35, 7168
    s_add_u32 s3, s34, 7168
    buffer_load_dwordx4 v57, s[44:47], s3 offen lds
    s_add_u32 m0, s35, 8192
    s_add_u32 s3, s34, 8192
    buffer_load_dwordx4 v58, s[44:47], s3 offen lds
    s_add_u32 s35, s35, 36864
    s_cmp_ge_u32 s35, 147456
    s_cselect_b32 s3, 147456, 0
    s_sub_u32 s35, s35, s3
    s_add_u32 s76, s76, 1
    s_cmp_lt_u32 s76, 4
    s_cbranch_scc1 L_W_wo
    s_waitcnt vmcnt(36)
    v_perm_b32 v64, v20, v16, v8
    v_perm_b32 v65, v28, v24, v8
    v_perm_b32 v66, v36, v32, v8
    v_perm_b32 v67, v44, v40, v8
    v_perm_b32 v68, v20, v16, v9
    v_perm_b32 v69, v28, v24, v9
    v_perm_b32 v70, v36, v32, v9
    v_perm_b32 v71, v44, v40, v9
    v_perm_b32 v72, v21, v17, v8
    v_perm_b32 v73, v29, v25, v8
    v_perm_b32 v74, v37, v33, v8
    v_perm_b32 v75, v45, v41, v8
    v_perm_b32 v76, v21, v17, v9
    v_perm_b32 v77, v29, v25, v9
    v_perm_b32 v78, v37, v33, v9
    v_perm_b32 v79, v45, v41, v9
    v_perm_b32 v80, v22, v18, v8
    v_perm_b32 v81, v30, v26, v8
    v_perm_b32 v82, v38, v34, v8
    v_perm_b32 v83, v46, v42, v8
    v_perm_b32 v84, v22, v18, v9
    v_perm_b32 v85, v30, v26, v9
    v_perm_b32 v86, v38, v34, v9
    v_perm_b32 v87, v46, v42, v9
    v_perm_b32 v88, v23, v19, v8
    v_perm_b32 v89, v31, v27, v8
    v_perm_b32 v90, v39, v35, v8
    v_perm_b32 v91, v47, v43, v8
    v_perm_b32 v92, v23, v19, v9
    v_perm_b32 v93, v31, v27, v9
    v_perm_b32 v94, v39, v35, v9
    v_perm_b32 v95, v47, v43, v9
    v_mov_b32 v6, 147456
    v_mov_b32 v7, 1
    s_lshl_b32 s3, s39, 12
    s_add_u32 s3, s3, 147456
    v_lshlrev_b32 v10, 4, v1
    v_add_u32 v12, s3, v10
    s_lshl_b32 s3, s39, 10
    s_add_u32 s3, s3, 147456
    v_add_u32 v13, s3, v10
    s_cmp_eq_u32 s39, 0
    s_cbranch_scc1 L_W_x0_0
    ds_write_b128 v12, v[64:67]
L_W_x0_0:
    ds_write_b128 v12, v[68:71] offset:1024
    ds_write_b128 v12, v[72:75] offset:2048
    ds_write_b128 v12, v[76:79] offset:3072
    s_waitcnt lgkmcnt(0)
    s_mov_b64 exec, 1
    ds_add_u32 v6, v7
    s_mov_b64 exec, -1
    s_mov_b32 s59, 0
L_W_sba0:
    ds_read_b32 v11, v6
    s_add_u32 s59, s59, 1
    s_waitcnt lgkmcnt(0)
    v_readfirstlane_b32 s3, v11
    s_nop 0
    s_cmp_ge_u32 s3, 4
    s_cbranch_scc1 L_W_sba0_ok
    s_sleep 1
    s_cmp_lt_u32 s59, 1000000
    s_cbranch_scc1 L_W_sba0
L_W_sba0_ok:
    ds_read_b128 v[96:99], v13 offset:0
    ds_read_b128 v[100:103], v13 offset:4096
    ds_read_b128 v[104:107], v13 offset:8192
    ds_read_b128 v[108:111], v13 offset:12288
    s_waitcnt lgkmcnt(0)
    s_cmp_eq_u32 s39, 0
    s_cbranch_scc0 L_W_x1_0
    v_mov_b32 v96, v64
    v_mov_b32 v97, v65
    v_mov_b32 v98, v66
    v_mov_b32 v99, v67
L_W_x1_0:
    s_waitcnt lgkmcnt(0)
    s_mov_b64 exec, 1
    ds_add_u32 v6, v7
    s_mov_b64 exec, -1
    s_mov_b32 s59, 0
L_W_sbb0:
    ds_read_b32 v11, v6
    s_add_u32 s59, s59, 1
    s_waitcnt lgkmcnt(0)
    v_readfirstlane_b32 s3, v11
    s_nop 0
    s_cmp_ge_u32 s3, 8
    s_cbranch_scc1 L_W_sbb0_ok
    s_sleep 1
    s_cmp_lt_u32 s59, 1000000
    s_cbranch_scc1 L_W_sbb0
L_W_sbb0_ok:
    s_cmp_eq_u32 s39, 0
    s_cbranch_scc1 L_W_x0_1
    ds_write_b128 v12, v[80:83]
L_W_x0_1:
    ds_write_b128 v12, v[84:87] offset:1024
    ds_write_b128 v12, v[88:91] offset:2048
    ds_write_b128 v12, v[92:95] offset:3072
    s_waitcnt lgkmcnt(0)
    s_mov_b64 exec, 1
    ds_add_u32 v6, v7
    s_mov_b64 exec, -1
    s_mov_b32 s59, 0
L_W_sba1:
    ds_read_b32 v11, v6
    s_add_u32 s59, s59, 1
    s_waitcnt lgkmcnt(0)
    v_readfirstlane_b32 s3, v11
    s_nop 0
    s_cmp_ge_u32 s3, 12
    s_cbranch_scc1 L_W_sba1_ok
    s_sleep 1
    s_cmp_lt_u32 s59, 1000000
    s_cbranch_scc1 L_W_sba1
L_W_sba1_ok:
    ds_read_b128 v[112:115], v13 offset:0
    ds_read_b128 v[116:119], v13 offset:4096
    ds_read_b128 v[120:123], v13 offset:8192
    ds_read_b128 v[124:127], v13 offset:12288
    s_waitcnt lgkmcnt(0)
    s_cmp_eq_u32 s39, 0
    s_cbranch_scc0 L_W_x1_1
    v_mov_b32 v112, v80
    v_mov_b32 v113, v81
    v_mov_b32 v114, v82
    v_mov_b32 v115, v83
L_W_x1_1:
    s_waitcnt vmcnt(0)
    s_branch L_W_gamma
L_W_mlpret:
L_W_gamma:
    s_barrier
    s_cmp_lt_u32 s39, 4
    s_cbranch_scc0 L_W_nohint0
    s_lshl_b32 s34, s56, 2
    s_add_u32 s34, s34, s39
    s_lshl_b32 s34, s34, 9
    s_add_u32 s58, s34, 13631488
    v_and_b32 v4, 7, v2
    v_lshl_add_u32 v4, v3, 3, v4
    v_lshlrev_b32 v4, 4, v4
    buffer_load_dwordx4 v[48:51], v4, s[4:7], s58 offen sc1
L_W_nohint0:
    v_lshrrev_b32 v11, 2, v2
    v_and_b32 v12, 3, v1
    v_lshrrev_b32 v13, 1, v11
    v_lshl_add_u32 v13, v3, 1, v13
    v_and_b32 v13, 3, v13
    v_lshlrev_b32 v13, 1, v13
    s_lshl_b32 s3, s39, 1
    v_lshrrev_b32 v14, 1, v12
    v_add_u32 v14, s3, v14
    v_xor_b32 v14, v14, v13
    v_lshl_add_u32 v11, v3, 2, v11
    v_mul_u32_u24 v11, 72, v11
    v_add_u32 v11, v11, v14
    v_lshlrev_b32 v11, 4, v11
    v_and_b32 v12, 1, v12
    v_lshl_add_u32 v11, v12, 3, v11
    v_add_u32 v12, 73728, v11
    ds_read_b64_tr_b16 v[128:129], v11 offset:0
    ds_read_b64_tr_b16 v[130:131], v11 offset:18432
    ds_read_b64_tr_b16 v[132:133], v11 offset:36864
    ds_read_b64_tr_b16 v[134:135], v11 offset:55296
    ds_read_b64_tr_b16 v[136:137], v12 offset:0
    ds_read_b64_tr_b16 v[138:139], v12 offset:18432
    ds_read_b64_tr_b16 v[140:141], v12 offset:36864
    ds_read_b64_tr_b16 v[142:143], v12 offset:55296
    ds_read_b64_tr_b16 v[144:145], v11 offset:256
    ds_read_b64_tr_b16 v[146:147], v11 offset:18688
    ds_read_b64_tr_b16 v[148:149], v11 offset:37120
    ds_read_b64_tr_b16 v[150:151], v11 offset:55552
    ds_read_b64_tr_b16 v[152:153], v12 offset:256
    ds_read_b64_tr_b16 v[154:155], v12 offset:18688
    ds_read_b64_tr_b16 v[156:157], v12 offset:37120
    ds_read_b64_tr_b16 v[158:159], v12 offset:55552
    ds_read_b64_tr_b16 v[160:161], v11 offset:512
    ds_read_b64_tr_b16 v[162:163], v11 offset:18944
    ds_read_b64_tr_b16 v[164:165], v11 offset:37376
    ds_read_b64_tr_b16 v[166:167], v11 offset:55808
    ds_read_b64_tr_b16 v[168:169], v12 offset:512
    ds_read_b64_tr_b16 v[170:171], v12 offset:18944
    ds_read_b64_tr_b16 v[172:173], v12 offset:37376
    ds_read_b64_tr_b16 v[174:175], v12 offset:55808
    ds_read_b64_tr_b16 v[176:177], v11 offset:768
    ds_read_b64_tr_b16 v[178:179], v11 offset:19200
    ds_read_b64_tr_b16 v[180:181], v11 offset:37632
    ds_read_b64_tr_b16 v[182:183], v11 offset:56064
    ds_read_b64_tr_b16 v[184:185], v12 offset:768
    ds_read_b64_tr_b16 v[186:187], v12 offset:19200
    ds_read_b64_tr_b16 v[188:189], v12 offset:37632
    ds_read_b64_tr_b16 v[190:191], v12 offset:56064
    v_and_b32 v40, 3, v2
    v_lshlrev_b32 v40, 8, v40
    v_lshl_add_u32 v41, v3, 4, v40
    v_add_u32 v41, 149504, v41
    v_lshl_add_u32 v42, v3, 3, v40
    v_add_u32 v42, 150528, v42
    v_lshlrev_b32 v43, 4, v2
    s_lshl_b32 s3, s39, 1
    s_add_u32 s3, s3, 150528
    v_add_u32 v43, s3, v43
    v_mov_b32 v44, 0xff
    v_lshlrev_b32 v45, 4, v2
    s_mul_i32 s76, s72, 9216
    s_add_u32 s76, s76, 6291456
    s_lshl_b32 s3, s39, 8
    s_add_u32 s76, s76, s3
    s_cmp_lt_u32 s39, 4
    s_cbranch_scc0 L_W_e3done
    ds_read_b64_tr_b16 v[192:193], v11 offset:1024
    ds_read_b64_tr_b16 v[194:195], v11 offset:19456
    ds_read_b64_tr_b16 v[196:197], v11 offset:37888
    ds_read_b64_tr_b16 v[198:199], v11 offset:56320
    ds_read_b64_tr_b16 v[200:201], v12 offset:1024
    ds_read_b64_tr_b16 v[202:203], v12 offset:19456
    ds_read_b64_tr_b16 v[204:205], v12 offset:37888
    ds_read_b64_tr_b16 v[206:207], v12 offset:56320
    v_and_b32 v244, 3, v1
    v_lshlrev_b32 v244, 3, v244
    v_lshrrev_b32_e64 v244, v244, s38
    v_bfe_u32 v240, v244, 0, 1
    v_bfe_u32 v245, v244, 1, 1
    v_lshl_or_b32 v240, v245, 16, v240
    v_bfe_u32 v241, v244, 2, 1
    v_bfe_u32 v245, v244, 3, 1
    v_lshl_or_b32 v241, v245, 16, v241
    v_bfe_u32 v242, v244, 4, 1
    v_bfe_u32 v245, v244, 5, 1
    v_lshl_or_b32 v242, v245, 16, v242
    v_bfe_u32 v243, v244, 6, 1
    v_bfe_u32 v245, v244, 7, 1
    v_lshl_or_b32 v243, v245, 16, v243
    v_lshlrev_b32 v5, 18, v3
    v_lshl_add_u32 v5, v2, 4, v5
    s_lshl_b32 s34, s39, 20
    s_lshl_b32 s35, s56, 10
    s_add_u32 s34, s34, s35
    s_lshl_b32 s35, s57, 8
    s_add_u32 s34, s34, s35
    s_add_u32 s78, s34, 1048576
    s_lshl_b32 s3, s39, 8
    s_add_u32 s3, s3, 149504
    v_lshlrev_b32 v10, 4, v2
    v_lshl_add_u32 v10, v3, 1, v10
    v_add_u32 v10, s3, v10
    v_and_b32 v46, 3, v2
    v_lshrrev_b32 v47, 2, v2
    s_mov_b32 s59, 0
    s_branch L_W_hint1
L_W_hint:
    buffer_load_dwordx4 v[48:51], v4, s[4:7], s58 offen sc1
L_W_hint1:
    s_add_u32 s59, s59, 1
    s_waitcnt vmcnt(0)
    v_cmp_eq_u32 vcc, s38, v50
    s_nop 0
    s_cmp_eq_u64 vcc, -1
    s_cbranch_scc1 L_W_e3
    s_cmp_lt_u32 s59, 40000
    s_cbranch_scc1 L_W_hint
L_W_e3:
    s_mov_b32 s34, s78
    buffer_load_dwordx4 v[208:211], v5, s[4:7], s34 offen sc1
    s_add_u32 s34, s34, 32768
    buffer_load_dwordx4 v[212:215], v5, s[4:7], s34 offen sc1
    s_add_u32 s34, s34, 32768
    buffer_load_dwordx4 v[216:219], v5, s[4:7], s34 offen sc1
    s_add_u32 s34, s34, 32768
    buffer_load_dwordx4 v[220:223], v5, s[4:7], s34 offen sc1
    s_add_u32 s34, s34, 32768
    buffer_load_dwordx4 v[224:227], v5, s[4:7], s34 offen sc1
    s_add_u32 s34, s34, 32768
    buffer_load_dwordx4 v[228:231], v5, s[4:7], s34 offen sc1
    s_add_u32 s34, s34, 32768
    buffer_load_dwordx4 v[232:235], v5, s[4:7], s34 offen sc1
    s_add_u32 s34, s34, 32768
    buffer_load_dwordx4 v[236:239], v5, s[4:7], s34 offen sc1
    v_mov_b32 v56, v48
    s_nop 1
    v_max_f32_dpp v56, v56, v56 quad_perm:[1,0,3,2] row_mask:0xf bank_mask:0xf
    s_nop 1
    v_max_f32_dpp v56, v56, v56 quad_perm:[2,3,0,1] row_mask:0xf bank_mask:0xf
    s_nop 1
    v_max_f32_dpp v56, v56, v56 row_half_mirror row_mask:0xf bank_mask:0xf
    v_mov_b32 v57, v56
    s_nop 1
    v_permlane16_swap_b32 v56, v57
    v_max_f32 v56, v56, v57
    v_mov_b32 v57, v56
    s_nop 1
    v_permlane32_swap_b32 v56, v57
    v_max_f32 v56, v56, v57
    v_sub_f32 v48, v48, v56
    v_exp_f32 v48, v48
    s_nop 0
    v_mul_f32 v57, v48, v49
    s_nop 1
    v_add_f32_dpp v57, v57, v57 quad_perm:[1,0,3,2] row_mask:0xf bank_mask:0xf
    s_nop 1
    v_add_f32_dpp v57, v57, v57 quad_perm:[2,3,0,1] row_mask:0xf bank_mask:0xf
    s_nop 1
    v_add_f32_dpp v57, v57, v57 row_half_mirror row_mask:0xf bank_mask:0xf
    v_mov_b32 v58, v57
    s_nop 1
    v_permlane16_swap_b32 v57, v58
    v_add_f32 v57, v57, v58
    v_mov_b32 v58, v57
    s_nop 1
    v_permlane32_swap_b32 v57, v58
    v_add_f32 v57, v57, v58
    v_rcp_f32 v57, v57
    v_mov_b32_dpp v60, v48 row_newbcast:0 row_mask:0xf bank_mask:0xf
    v_mov_b32_dpp v61, v48 row_newbcast:1 row_mask:0xf bank_mask:0xf
    v_mov_b32_dpp v62, v48 row_newbcast:2 row_mask:0xf bank_mask:0xf
    v_mov_b32_dpp v63, v48 row_newbcast:3 row_mask:0xf bank_mask:0xf
    v_mov_b32_dpp v64, v48 row_newbcast:4 row_mask:0xf bank_mask:0xf
    v_mov_b32_dpp v65, v48 row_newbcast:5 row_mask:0xf bank_mask:0xf
    v_mov_b32_dpp v66, v48 row_newbcast:6 row_mask:0xf bank_mask:0xf
    v_mov_b32_dpp v67, v48 row_newbcast:7 row_mask:0xf bank_mask:0xf
    v_cvt_pk_bf16_f32 v52, v60, v61
    v_cvt_pk_bf16_f32 v53, v62, v63
    v_cvt_pk_bf16_f32 v54, v64, v65
    v_cvt_pk_bf16_f32 v55, v66, v67
    v_lshlrev_b32 v58, 16, v52
    v_and_b32 v59, 0xffff0000, v52
    v_sub_f32 v60, v60, v58
    v_sub_f32 v61, v61, v59
    v_lshlrev_b32 v58, 16, v53
    v_and_b32 v59, 0xffff0000, v53
    v_sub_f32 v62, v62, v58
    v_sub_f32 v63, v63, v59
    v_lshlrev_b32 v58, 16, v54
    v_and_b32 v59, 0xffff0000, v54
    v_sub_f32 v64, v64, v58
    v_sub_f32 v65, v65, v59
    v_lshlrev_b32 v58, 16, v55
    v_and_b32 v59, 0xffff0000, v55
    v_sub_f32 v66, v66, v58
    v_sub_f32 v67, v67, v59
    v_cvt_pk_bf16_f32 v48, v60, v61
    v_cvt_pk_bf16_f32 v49, v62, v63
    v_cvt_pk_bf16_f32 v50, v64, v65
    v_cvt_pk_bf16_f32 v51, v66, v67
    v_cmp_eq_u32 vcc, 0, v46
    v_cmp_eq_u32 s[20:21], 1, v46
    s_nop 1
    v_cndmask_b32 v48, 0, v48, s[20:21]
    v_cndmask_b32 v49, 0, v49, s[20:21]
    v_cndmask_b32 v50, 0, v50, s[20:21]
    v_cndmask_b32 v51, 0, v51, s[20:21]
    v_cndmask_b32 v48, v48, v52, vcc
    v_cndmask_b32 v49, v49, v53, vcc
    v_cndmask_b32 v50, v50, v54, vcc
    v_cndmask_b32 v51, v51, v55, vcc
    v_cmp_eq_u32 vcc, 0, v47
    s_nop 1
    v_cndmask_b32 v68, 0, v48, vcc
    v_cndmask_b32 v69, 0, v49, vcc
    v_cndmask_b32 v70, 0, v50, vcc
    v_cndmask_b32 v71, 0, v51, vcc
    v_cmp_eq_u32 vcc, 1, v47
    s_nop 1
    v_cndmask_b32 v72, 0, v48, vcc
    v_cndmask_b32 v73, 0, v49, vcc
    v_cndmask_b32 v74, 0, v50, vcc
    v_cndmask_b32 v75, 0, v51, vcc
    v_cmp_eq_u32 vcc, 2, v47
    s_nop 1
    v_cndmask_b32 v76, 0, v48, vcc
    v_cndmask_b32 v77, 0, v49, vcc
    v_cndmask_b32 v78, 0, v50, vcc
    v_cndmask_b32 v79, 0, v51, vcc
    v_cmp_eq_u32 vcc, 3, v47
    s_nop 1
    v_cndmask_b32 v80, 0, v48, vcc
    v_cndmask_b32 v81, 0, v49, vcc
    v_cndmask_b32 v82, 0, v50, vcc
    v_cndmask_b32 v83, 0, v51, vcc
L_W_e3l:
    s_waitcnt vmcnt(0)
    v_xor_b32 v208, v208, v240
    v_xor_b32 v209, v209, v241
    v_xor_b32 v210, v210, v242
    v_xor_b32 v211, v211, v243
    v_xor_b32 v212, v212, v240
    v_xor_b32 v213, v213, v241
    v_xor_b32 v214, v214, v242
    v_xor_b32 v215, v215, v243
    v_xor_b32 v216, v216, v240
    v_xor_b32 v217, v217, v241
    v_xor_b32 v218, v218, v242
    v_xor_b32 v219, v219, v243
    v_xor_b32 v220, v220, v240
    v_xor_b32 v221, v221, v241
    v_xor_b32 v222, v222, v242
    v_xor_b32 v223, v223, v243
    v_xor_b32 v224, v224, v240
    v_xor_b32 v225, v225, v241
    v_xor_b32 v226, v226, v242
    v_xor_b32 v227, v227, v243
    v_xor_b32 v228, v228, v240
    v_xor_b32 v229, v229, v241
    v_xor_b32 v230, v230, v242
    v_xor_b32 v231, v231, v243
    v_xor_b32 v232, v232, v240
    v_xor_b32 v233, v233, v241
    v_xor_b32 v234, v234, v242
    v_xor_b32 v235, v235, v243
    v_xor_b32 v236, v236, v240
    v_xor_b32 v237, v237, v241
    v_xor_b32 v238, v238, v242
    v_xor_b32 v239, v239, v243
    v_perm_b32 v16, v212, v208, v8
    v_perm_b32 v17, v220, v216, v8
    v_perm_b32 v18, v228, v224, v8
    v_perm_b32 v19, v236, v232, v8
    v_perm_b32 v20, v212, v208, v9
    v_perm_b32 v21, v220, v216, v9
    v_perm_b32 v22, v228, v224, v9
    v_perm_b32 v23, v236, v232, v9
    v_perm_b32 v24, v213, v209, v8
    v_perm_b32 v25, v221, v217, v8
    v_perm_b32 v26, v229, v225, v8
    v_perm_b32 v27, v237, v233, v8
    v_perm_b32 v28, v213, v209, v9
    v_perm_b32 v29, v221, v217, v9
    v_perm_b32 v30, v229, v225, v9
    v_perm_b32 v31, v237, v233, v9
    v_perm_b32 v32, v214, v210, v8
    v_perm_b32 v33, v222, v218, v8
    v_perm_b32 v34, v230, v226, v8
    v_perm_b32 v35, v238, v234, v8
    v_perm_b32 v36, v214, v210, v9
    v_perm_b32 v37, v222, v218, v9
    v_perm_b32 v38, v230, v226, v9
    v_perm_b32 v39, v238, v234, v9
    v_perm_b32 v84, v215, v211, v8
    v_perm_b32 v85, v223, v219, v8
    v_perm_b32 v86, v231, v227, v8
    v_perm_b32 v87, v239, v235, v8
    v_perm_b32 v88, v215, v211, v9
    v_perm_b32 v89, v223, v219, v9
    v_perm_b32 v90, v231, v227, v9
    v_perm_b32 v91, v239, v235, v9
    v_mfma_f32_16x16x32_bf16 v[48:51], v[68:71], v[16:19], 0
    v_mfma_f32_16x16x32_bf16 v[52:55], v[68:71], v[32:35], 0
    v_mfma_f32_16x16x32_bf16 v[48:51], v[72:75], v[20:23], v[48:51]
    v_mfma_f32_16x16x32_bf16 v[52:55], v[72:75], v[36:39], v[52:55]
    v_mfma_f32_16x16x32_bf16 v[48:51], v[76:79], v[24:27], v[48:51]
    v_mfma_f32_16x16x32_bf16 v[52:55], v[76:79], v[84:87], v[52:55]
    v_mfma_f32_16x16x32_bf16 v[48:51], v[80:83], v[28:31], v[48:51]
    v_mfma_f32_16x16x32_bf16 v[52:55], v[80:83], v[88:91], v[52:55]
    v_or3_b32 v244, v208, v209, v210
    v_or3_b32 v244, v244, v211, v212
    v_or3_b32 v244, v244, v213, v214
    v_or3_b32 v244, v244, v215, v216
    v_or3_b32 v244, v244, v217, v218
    v_or3_b32 v244, v244, v219, v220
    v_or3_b32 v244, v244, v221, v222
    v_or3_b32 v244, v244, v223, v224
    v_or3_b32 v244, v244, v225, v226
    v_or3_b32 v244, v244, v227, v228
    v_or3_b32 v244, v244, v229, v230
    v_or3_b32 v244, v244, v231, v232
    v_or3_b32 v244, v244, v233, v234
    v_or3_b32 v244, v244, v235, v236
    v_or3_b32 v244, v244, v237, v238
    v_or_b32 v244, v244, v239
    v_and_b32 v244, 0x10001, v244
    v_cmp_ne_u32 vcc, 0, v244
    s_cbranch_vccz L_W_e3ok
    s_add_u32 s59, s59, 1
    s_cmp_lt_u32 s59, 40000
    s_cbranch_scc0 L_W_e3ok
    s_mov_b32 s34, s78
    buffer_load_dwordx4 v[208:211], v5, s[4:7], s34 offen sc1
    s_add_u32 s34, s34, 32768
    buffer_load_dwordx4 v[212:215], v5, s[4:7], s34 offen sc1
    s_add_u32 s34, s34, 32768
    buffer_load_dwordx4 v[216:219], v5, s[4:7], s34 offen sc1
    s_add_u32 s34, s34, 32768
    buffer_load_dwordx4 v[220:223], v5, s[4:7], s34 offen sc1
    s_add_u32 s34, s34, 32768
    buffer_load_dwordx4 v[224:227], v5, s[4:7], s34 offen sc1
    s_add_u32 s34, s34, 32768
    buffer_load_dwordx4 v[228:231], v5, s[4:7], s34 offen sc1
    s_add_u32 s34, s34, 32768
    buffer_load_dwordx4 v[232:235], v5, s[4:7], s34 offen sc1
    s_add_u32 s34, s34, 32768
    buffer_load_dwordx4 v[236:239], v5, s[4:7], s34 offen sc1
    s_branch L_W_e3l
L_W_e3ok:
    v_add_f32 v48, v48, v49
    v_add_f32 v52, v52, v53
    v_mul_f32 v48, v48, v57
    v_mul_f32 v52, v52, v57
    v_cvt_pk_bf16_f32 v48, v48, v52
    ds_write_b16 v10, v48
    ds_write_b16_d16_hi v10, v48 offset:8
L_W_e3done:
    s_waitcnt lgkmcnt(0)
    s_barrier
    s_cmp_lt_u32 s39, 4
    s_cbranch_scc0 L_W_Ddone
    ds_read_b128 v[16:19], v41 offset:0
    ds_read_b128 v[20:23], v41 offset:64
    ds_read_b128 v[24:27], v41 offset:128
    ds_read_b128 v[28:31], v41 offset:192
    s_waitcnt lgkmcnt(3)
    v_mfma_f32_16x16x32_bf16 v[64:67], v[16:19], v[96:99], 0
    v_mfma_f32_16x16x32_bf16 v[68:71], v[16:19], v[112:115], 0
    s_waitcnt lgkmcnt(2)
    v_mfma_f32_16x16x32_bf16 v[64:67], v[20:23], v[100:103], v[64:67]
    v_mfma_f32_16x16x32_bf16 v[68:71], v[20:23], v[116:119], v[68:71]
    s_waitcnt lgkmcnt(1)
    v_mfma_f32_16x16x32_bf16 v[64:67], v[24:27], v[104:107], v[64:67]
    v_mfma_f32_16x16x32_bf16 v[68:71], v[24:27], v[120:123], v[68:71]
    s_waitcnt lgkmcnt(0)
    v_mfma_f32_16x16x32_bf16 v[64:67], v[28:31], v[108:111], v[64:67]
    v_mfma_f32_16x16x32_bf16 v[68:71], v[28:31], v[124:127], v[68:71]
    s_mov_b64 exec, 0xffff
    s_nop 5
    v_cvt_pk_bf16_f32 v64, v64, v65
    v_cvt_pk_bf16_f32 v66, v66, v67
    ds_write_b16 v43, v64
    ds_write_b16_d16_hi v43, v64 offset:256
    ds_write_b16 v43, v66 offset:512
    ds_write_b16_d16_hi v43, v66 offset:768
    v_cvt_pk_bf16_f32 v68, v68, v69
    v_cvt_pk_bf16_f32 v70, v70, v71
    ds_write_b16 v43, v68 offset:8
    ds_write_b16_d16_hi v43, v68 offset:264
    ds_write_b16 v43, v70 offset:520
    ds_write_b16_d16_hi v43, v70 offset:776
    s_mov_b64 exec, -1
L_W_Ddone:
    s_waitcnt lgkmcnt(0)
    s_barrier
    ds_read_b64 v[16:17], v42 offset:0
    ds_read_b64 v[18:19], v42 offset:32
    ds_read_b64 v[20:21], v42 offset:64
    ds_read_b64 v[22:23], v42 offset:96
    ds_read_b64 v[24:25], v42 offset:128
    ds_read_b64 v[26:27], v42 offset:160
    ds_read_b64 v[28:29], v42 offset:192
    ds_read_b64 v[30:31], v42 offset:224
    s_waitcnt lgkmcnt(6)
    v_mfma_f32_16x16x32_bf16 v[64:67], v[16:19], v[128:131], 0
    v_mfma_f32_16x16x32_bf16 v[68:71], v[16:19], v[144:147], 0
    v_mfma_f32_16x16x32_bf16 v[72:75], v[16:19], v[160:163], 0
    v_mfma_f32_16x16x32_bf16 v[76:79], v[16:19], v[176:179], 0
    s_waitcnt lgkmcnt(4)
    v_mfma_f32_16x16x32_bf16 v[64:67], v[20:23], v[132:135], v[64:67]
    v_mfma_f32_16x16x32_bf16 v[68:71], v[20:23], v[148:151], v[68:71]
    v_mfma_f32_16x16x32_bf16 v[72:75], v[20:23], v[164:167], v[72:75]
    v_mfma_f32_16x16x32_bf16 v[76:79], v[20:23], v[180:183], v[76:79]
    s_waitcnt lgkmcnt(2)
    v_mfma_f32_16x16x32_bf16 v[64:67], v[24:27], v[136:139], v[64:67]
    v_mfma_f32_16x16x32_bf16 v[68:71], v[24:27], v[152:155], v[68:71]
    v_mfma_f32_16x16x32_bf16 v[72:75], v[24:27], v[168:171], v[72:75]
    v_mfma_f32_16x16x32_bf16 v[76:79], v[24:27], v[184:187], v[76:79]
    s_waitcnt lgkmcnt(0)
    v_mfma_f32_16x16x32_bf16 v[64:67], v[28:31], v[140:143], v[64:67]
    v_mfma_f32_16x16x32_bf16 v[68:71], v[28:31], v[156:159], v[68:71]
    v_mfma_f32_16x16x32_bf16 v[72:75], v[28:31], v[172:175], v[72:75]
    v_mfma_f32_16x16x32_bf16 v[76:79], v[28:31], v[188:191], v[76:79]
    s_cmp_lt_u32 s39, 4
    s_cbranch_scc0 L_W_E4
    v_mfma_f32_16x16x32_bf16 v[80:83], v[16:19], v[192:195], 0
    v_mfma_f32_16x16x32_bf16 v[80:83], v[20:23], v[196:199], v[80:83]
    v_mfma_f32_16x16x32_bf16 v[80:83], v[24:27], v[200:203], v[80:83]
    v_mfma_f32_16x16x32_bf16 v[80:83], v[28:31], v[204:207], v[80:83]
L_W_E4:
    s_mov_b64 exec, 0xffff
    v_bfi_b32 v64, v44, s60, v64
    v_bfi_b32 v65, v44, s61, v65
    v_bfi_b32 v66, v44, s62, v66
    v_bfi_b32 v67, v44, s63, v67
    buffer_store_dwordx4 v[64:67], v45, s[4:7], s76 offen sc1
    s_add_u32 s76, s76, 2048
    v_bfi_b32 v68, v44, s60, v68
    v_bfi_b32 v69, v44, s61, v69
    v_bfi_b32 v70, v44, s62, v70
    v_bfi_b32 v71, v44, s63, v71
    buffer_store_dwordx4 v[68:71], v45, s[4:7], s76 offen sc1
    s_add_u32 s76, s76, 2048
    v_bfi_b32 v72, v44, s60, v72
    v_bfi_b32 v73, v44, s61, v73
    v_bfi_b32 v74, v44, s62, v74
    v_bfi_b32 v75, v44, s63, v75
    buffer_store_dwordx4 v[72:75], v45, s[4:7], s76 offen sc1
    s_add_u32 s76, s76, 2048
    v_bfi_b32 v76, v44, s60, v76
    v_bfi_b32 v77, v44, s61, v77
    v_bfi_b32 v78, v44, s62, v78
    v_bfi_b32 v79, v44, s63, v79
    buffer_store_dwordx4 v[76:79], v45, s[4:7], s76 offen sc1
    s_add_u32 s76, s76, 2048
    s_cmp_lt_u32 s39, 4
    s_cbranch_scc0 L_W_E5
    v_bfi_b32 v80, v44, s60, v80
    v_bfi_b32 v81, v44, s61, v81
    v_bfi_b32 v82, v44, s62, v82
    v_bfi_b32 v83, v44, s63, v83
    buffer_store_dwordx4 v[80:83], v45, s[4:7], s76 offen sc1
L_W_E5:
    s_mov_b64 exec, -1
    s_branch L_fin
L_MLP:
    s_waitcnt vmcnt(9)
    v_cmp_gt_u32 vcc, 32, v1
    s_nop 1
    v_cndmask_b32 v226, 0, v226, vcc
    v_lshlrev_b32 v44, 16, v222
    v_and_b32 v45, 0xffff0000, v222
    v_lshlrev_b32 v46, 16, v223
    v_and_b32 v47, 0xffff0000, v223
    v_lshlrev_b32 v48, 16, v224
    v_and_b32 v49, 0xffff0000, v224
    v_lshlrev_b32 v50, 16, v225
    v_and_b32 v51, 0xffff0000, v225
    v_lshlrev_b32 v52, 16, v226
    v_and_b32 v53, 0xffff0000, v226
    v_add_f32 v54, v44, v45
    v_add_f32 v55, v46, v47
    v_add_f32 v56, v48, v49
    v_add_f32 v57, v50, v51
    v_add_f32 v58, v52, v53
    v_add_f32 v54, v54, v55
    v_add_f32 v56, v56, v57
    v_add_f32 v54, v54, v58
    v_add_f32 v54, v54, v56
    s_nop 1
    v_add_f32_dpp v54, v54, v54 row_shr:1 row_mask:0xf bank_mask:0xf bound_ctrl:0
    s_nop 1
    v_add_f32_dpp v54, v54, v54 row_shr:2 row_mask:0xf bank_mask:0xf bound_ctrl:0
    s_nop 1
    v_add_f32_dpp v54, v54, v54 row_shr:4 row_mask:0xf bank_mask:0xf bound_ctrl:0
    s_nop 1
    v_add_f32_dpp v54, v54, v54 row_shr:8 row_mask:0xf bank_mask:0xf bound_ctrl:0
    s_nop 1
    v_add_f32_dpp v54, v54, v54 row_bcast:15 row_mask:0xa bank_mask:0xf
    s_nop 1
    v_add_f32_dpp v54, v54, v54 row_bcast:31 row_mask:0xc bank_mask:0xf
    s_nop 0
    v_readlane_b32 s64, v54, 63
    s_mov_b32 s3, 0x3ae38e39
    s_nop 0
    v_mov_b32 v55, s64
    v_mul_f32 v55, s3, v55
    v_sub_f32 v44, v44, v55
    v_sub_f32 v45, v45, v55
    v_sub_f32 v46, v46, v55
    v_sub_f32 v47, v47, v55
    v_sub_f32 v48, v48, v55
    v_sub_f32 v49, v49, v55
    v_sub_f32 v50, v50, v55
    v_sub_f32 v51, v51, v55
    v_sub_f32 v52, v52, v55
    v_sub_f32 v53, v53, v55
    v_cndmask_b32 v52, 0, v52, vcc
    v_cndmask_b32 v53, 0, v53, vcc
    v_mul_f32 v54, v44, v44
    v_mul_f32 v56, v45, v45
    v_fmac_f32 v54, v46, v46
    v_fmac_f32 v56, v47, v47
    v_fmac_f32 v54, v48, v48
    v_fmac_f32 v56, v49, v49
    v_fmac_f32 v54, v50, v50
    v_fmac_f32 v56, v51, v51
    v_fmac_f32 v54, v52, v52
    v_fmac_f32 v56, v53, v53
    v_add_f32 v54, v54, v56
    s_nop 1
    v_add_f32_dpp v54, v54, v54 row_shr:1 row_mask:0xf bank_mask:0xf bound_ctrl:0
    s_nop 1
    v_add_f32_dpp v54, v54, v54 row_shr:2 row_mask:0xf bank_mask:0xf bound_ctrl:0
    s_nop 1
    v_add_f32_dpp v54, v54, v54 row_shr:4 row_mask:0xf bank_mask:0xf bound_ctrl:0
    s_nop 1
    v_add_f32_dpp v54, v54, v54 row_shr:8 row_mask:0xf bank_mask:0xf bound_ctrl:0
    s_nop 1
    v_add_f32_dpp v54, v54, v54 row_bcast:15 row_mask:0xa bank_mask:0xf
    s_nop 1
    v_add_f32_dpp v54, v54, v54 row_bcast:31 row_mask:0xc bank_mask:0xf
    s_nop 0
    v_readlane_b32 s64, v54, 63
    v_mov_b32 v56, 0x3727c5ac
    s_nop 0
    v_mov_b32 v54, s64
    v_fmac_f32 v56, s3, v54
    v_rsq_f32 v56, v56
    v_lshlrev_b32 v227, 16, v227
    v_sub_f32 v227, v227, v55
    v_mul_f32 v227, v227, v56
    v_mov_b32 v228, 0xc0135761
    v_mov_b32 v229, 0xc0135761
    v_mov_b32 v230, 0xbdd2d3e8
    v_mov_b32 v231, 0xbdd2d3e8
    v_mov_b32 v232, 1.0
    v_mov_b32 v233, 1.0
    s_waitcnt vmcnt(0)
    v_lshlrev_b32 v128, 16, v192
    v_and_b32 v129, 0xffff0000, v192
    v_lshlrev_b32 v130, 16, v193
    v_and_b32 v131, 0xffff0000, v193
    v_lshlrev_b32 v132, 16, v194
    v_and_b32 v133, 0xffff0000, v194
    v_lshlrev_b32 v134, 16, v195
    v_and_b32 v135, 0xffff0000, v195
    v_lshlrev_b32 v136, 16, v196
    v_and_b32 v137, 0xffff0000, v196
    v_lshlrev_b32 v138, 16, v197
    v_and_b32 v139, 0xffff0000, v197
    v_lshlrev_b32 v140, 16, v198
    v_and_b32 v141, 0xffff0000, v198
    v_lshlrev_b32 v142, 16, v199
    v_and_b32 v143, 0xffff0000, v199
    v_lshlrev_b32 v144, 16, v200
    v_and_b32 v145, 0xffff0000, v200
    v_lshlrev_b32 v146, 16, v202
    v_and_b32 v147, 0xffff0000, v202
    v_lshlrev_b32 v148, 16, v203
    v_and_b32 v149, 0xffff0000, v203
    v_lshlrev_b32 v150, 16, v204
    v_and_b32 v151, 0xffff0000, v204
    v_lshlrev_b32 v152, 16, v205
    v_and_b32 v153, 0xffff0000, v205
    v_lshlrev_b32 v154, 16, v206
    v_and_b32 v155, 0xffff0000, v206
    v_lshlrev_b32 v156, 16, v207
    v_and_b32 v157, 0xffff0000, v207
    v_lshlrev_b32 v158, 16, v208
    v_and_b32 v159, 0xffff0000, v208
    v_lshlrev_b32 v160, 16, v209
    v_and_b32 v161, 0xffff0000, v209
    v_lshlrev_b32 v162, 16, v210
    v_and_b32 v163, 0xffff0000, v210
    v_lshlrev_b32 v164, 16, v212
    v_and_b32 v165, 0xffff0000, v212
    v_lshlrev_b32 v166, 16, v213
    v_and_b32 v167, 0xffff0000, v213
    v_lshlrev_b32 v168, 16, v214
    v_and_b32 v169, 0xffff0000, v214
    v_lshlrev_b32 v170, 16, v215
    v_and_b32 v171, 0xffff0000, v215
    v_lshlrev_b32 v172, 16, v216
    v_and_b32 v173, 0xffff0000, v216
    v_lshlrev_b32 v174, 16, v217
    v_and_b32 v175, 0xffff0000, v217
    v_lshlrev_b32 v176, 16, v218
    v_and_b32 v177, 0xffff0000, v218
    v_lshlrev_b32 v178, 16, v219
    v_and_b32 v179, 0xffff0000, v219
    v_lshlrev_b32 v180, 16, v220
    v_and_b32 v181, 0xffff0000, v220
    s_cmp_eq_u32 s79, 1
    s_cbranch_scc1 L_W_prepret
L_MLP_go:
    s_mov_b32 s65, 0
L_MLP_loop:
    v_readlane_b32 s64, v227, s65
    v_mov_b32 v62, 0
    v_mov_b32 v63, 0
    v_pk_fma_f32 v[44:45], v[128:129], s[64:65], v[146:147] op_sel_hi:[1,0,1]
    v_pk_fma_f32 v[50:51], v[130:131], s[64:65], v[148:149] op_sel_hi:[1,0,1]
    v_pk_fma_f32 v[56:57], v[132:133], s[64:65], v[150:151] op_sel_hi:[1,0,1]
    v_pk_mul_f32 v[46:47], v[44:45], v[44:45]
    v_pk_mul_f32 v[52:53], v[50:51], v[50:51]
    v_pk_mul_f32 v[58:59], v[56:57], v[56:57]
    v_pk_fma_f32 v[46:47], v[46:47], v[230:231], v[228:229]
    v_pk_fma_f32 v[52:53], v[52:53], v[230:231], v[228:229]
    v_pk_fma_f32 v[58:59], v[58:59], v[230:231], v[228:229]
    v_pk_mul_f32 v[46:47], v[46:47], v[44:45]
    v_pk_mul_f32 v[52:53], v[52:53], v[50:51]
    v_pk_mul_f32 v[58:59], v[58:59], v[56:57]
    v_exp_f32 v46, v46
    v_exp_f32 v47, v47
    v_exp_f32 v52, v52
    v_exp_f32 v53, v53
    v_exp_f32 v58, v58
    v_exp_f32 v59, v59
    v_pk_mul_f32 v[48:49], v[44:45], v[164:165]
    v_pk_mul_f32 v[54:55], v[50:51], v[166:167]
    v_pk_mul_f32 v[60:61], v[56:57], v[168:169]
    v_pk_add_f32 v[46:47], v[46:47], v[232:233]
    v_pk_add_f32 v[52:53], v[52:53], v[232:233]
    v_pk_add_f32 v[58:59], v[58:59], v[232:233]
    v_rcp_f32 v46, v46
    v_rcp_f32 v47, v47
    v_rcp_f32 v52, v52
    v_rcp_f32 v53, v53
    v_rcp_f32 v58, v58
    v_rcp_f32 v59, v59
    v_pk_fma_f32 v[62:63], v[48:49], v[46:47], v[62:63]
    v_pk_fma_f32 v[62:63], v[54:55], v[52:53], v[62:63]
    v_pk_fma_f32 v[62:63], v[60:61], v[58:59], v[62:63]
    v_pk_fma_f32 v[44:45], v[134:135], s[64:65], v[152:153] op_sel_hi:[1,0,1]
    v_pk_fma_f32 v[50:51], v[136:137], s[64:65], v[154:155] op_sel_hi:[1,0,1]
    v_pk_fma_f32 v[56:57], v[138:139], s[64:65], v[156:157] op_sel_hi:[1,0,1]
    v_pk_mul_f32 v[46:47], v[44:45], v[44:45]
    v_pk_mul_f32 v[52:53], v[50:51], v[50:51]
    v_pk_mul_f32 v[58:59], v[56:57], v[56:57]
    v_pk_fma_f32 v[46:47], v[46:47], v[230:231], v[228:229]
    v_pk_fma_f32 v[52:53], v[52:53], v[230:231], v[228:229]
    v_pk_fma_f32 v[58:59], v[58:59], v[230:231], v[228:229]
    v_pk_mul_f32 v[46:47], v[46:47], v[44:45]
    v_pk_mul_f32 v[52:53], v[52:53], v[50:51]
    v_pk_mul_f32 v[58:59], v[58:59], v[56:57]
    v_exp_f32 v46, v46
    v_exp_f32 v47, v47
    v_exp_f32 v52, v52
    v_exp_f32 v53, v53
    v_exp_f32 v58, v58
    v_exp_f32 v59, v59
    v_pk_mul_f32 v[48:49], v[44:45], v[170:171]
    v_pk_mul_f32 v[54:55], v[50:51], v[172:173]
    v_pk_mul_f32 v[60:61], v[56:57], v[174:175]
    v_pk_add_f32 v[46:47], v[46:47], v[232:233]
    v_pk_add_f32 v[52:53], v[52:53], v[232:233]
    v_pk_add_f32 v[58:59], v[58:59], v[232:233]
    v_rcp_f32 v46, v46
    v_rcp_f32 v47, v47
    v_rcp_f32 v52, v52
    v_rcp_f32 v53, v53
    v_rcp_f32 v58, v58
    v_rcp_f32 v59, v59
    v_pk_fma_f32 v[62:63], v[48:49], v[46:47], v[62:63]
    v_pk_fma_f32 v[62:63], v[54:55], v[52:53], v[62:63]
    v_pk_fma_f32 v[62:63], v[60:61], v[58:59], v[62:63]
    v_pk_fma_f32 v[44:45], v[140:141], s[64:65], v[158:159] op_sel_hi:[1,0,1]
    v_pk_fma_f32 v[50:51], v[142:143], s[64:65], v[160:161] op_sel_hi:[1,0,1]
    v_pk_fma_f32 v[56:57], v[144:145], s[64:65], v[162:163] op_sel_hi:[1,0,1]
    v_pk_mul_f32 v[46:47], v[44:45], v[44:45]
    v_pk_mul_f32 v[52:53], v[50:51], v[50:51]
    v_pk_mul_f32 v[58:59], v[56:57], v[56:57]
    v_pk_fma_f32 v[46:47], v[46:47], v[230:231], v[228:229]
    v_pk_fma_f32 v[52:53], v[52:53], v[230:231], v[228:229]
    v_pk_fma_f32 v[58:59], v[58:59], v[230:231], v[228:229]
    v_pk_mul_f32 v[46:47], v[46:47], v[44:45]
    v_pk_mul_f32 v[52:53], v[52:53], v[50:51]
    v_pk_mul_f32 v[58:59], v[58:59], v[56:57]
    v_exp_f32 v46, v46
    v_exp_f32 v47, v47
    v_exp_f32 v52, v52
    v_exp_f32 v53, v53
    v_exp_f32 v58, v58
    v_exp_f32 v59, v59
    v_pk_mul_f32 v[48:49], v[44:45], v[176:177]
    v_pk_mul_f32 v[54:55], v[50:51], v[178:179]
    v_pk_mul_f32 v[60:61], v[56:57], v[180:181]
    v_pk_add_f32 v[46:47], v[46:47], v[232:233]
    v_pk_add_f32 v[52:53], v[52:53], v[232:233]
    v_pk_add_f32 v[58:59], v[58:59], v[232:233]
    v_rcp_f32 v46, v46
    v_rcp_f32 v47, v47
    v_rcp_f32 v52, v52
    v_rcp_f32 v53, v53
    v_rcp_f32 v58, v58
    v_rcp_f32 v59, v59
    v_pk_fma_f32 v[62:63], v[48:49], v[46:47], v[62:63]
    v_pk_fma_f32 v[62:63], v[54:55], v[52:53], v[62:63]
    v_pk_fma_f32 v[62:63], v[60:61], v[58:59], v[62:63]
    v_add_f32 v62, v62, v63
    s_set_gpr_idx_on s65, gpr_idx(DST)
    v_mov_b32 v182, v62
    s_set_gpr_idx_off
    s_add_u32 s65, s65, 1
    s_cmp_lt_u32 s65, s71
    s_cbranch_scc1 L_MLP_loop
    v_add_f32_dpp v182, v182, v182 row_shr:1 row_mask:0xf bank_mask:0xf bound_ctrl:0
    v_add_f32_dpp v183, v183, v183 row_shr:1 row_mask:0xf bank_mask:0xf bound_ctrl:0
    v_add_f32_dpp v184, v184, v184 row_shr:1 row_mask:0xf bank_mask:0xf bound_ctrl:0
    v_add_f32_dpp v185, v185, v185 row_shr:1 row_mask:0xf bank_mask:0xf bound_ctrl:0
    v_add_f32_dpp v186, v186, v186 row_shr:1 row_mask:0xf bank_mask:0xf bound_ctrl:0
    v_add_f32_dpp v187, v187, v187 row_shr:1 row_mask:0xf bank_mask:0xf bound_ctrl:0
    v_add_f32_dpp v188, v188, v188 row_shr:1 row_mask:0xf bank_mask:0xf bound_ctrl:0
    v_add_f32_dpp v189, v189, v189 row_shr:1 row_mask:0xf bank_mask:0xf bound_ctrl:0
    v_add_f32_dpp v190, v190, v190 row_shr:1 row_mask:0xf bank_mask:0xf bound_ctrl:0
    v_add_f32_dpp v182, v182, v182 row_shr:2 row_mask:0xf bank_mask:0xf bound_ctrl:0
    v_add_f32_dpp v183, v183, v183 row_shr:2 row_mask:0xf bank_mask:0xf bound_ctrl:0
    v_add_f32_dpp v184, v184, v184 row_shr:2 row_mask:0xf bank_mask:0xf bound_ctrl:0
    v_add_f32_dpp v185, v185, v185 row_shr:2 row_mask:0xf bank_mask:0xf bound_ctrl:0
    v_add_f32_dpp v186, v186, v186 row_shr:2 row_mask:0xf bank_mask:0xf bound_ctrl:0
    v_add_f32_dpp v187, v187, v187 row_shr:2 row_mask:0xf bank_mask:0xf bound_ctrl:0
    v_add_f32_dpp v188, v188, v188 row_shr:2 row_mask:0xf bank_mask:0xf bound_ctrl:0
    v_add_f32_dpp v189, v189, v189 row_shr:2 row_mask:0xf bank_mask:0xf bound_ctrl:0
    v_add_f32_dpp v190, v190, v190 row_shr:2 row_mask:0xf bank_mask:0xf bound_ctrl:0
    v_add_f32_dpp v182, v182, v182 row_shr:4 row_mask:0xf bank_mask:0xf bound_ctrl:0
    v_add_f32_dpp v183, v183, v183 row_shr:4 row_mask:0xf bank_mask:0xf bound_ctrl:0
    v_add_f32_dpp v184, v184, v184 row_shr:4 row_mask:0xf bank_mask:0xf bound_ctrl:0
    v_add_f32_dpp v185, v185, v185 row_shr:4 row_mask:0xf bank_mask:0xf bound_ctrl:0
    v_add_f32_dpp v186, v186, v186 row_shr:4 row_mask:0xf bank_mask:0xf bound_ctrl:0
    v_add_f32_dpp v187, v187, v187 row_shr:4 row_mask:0xf bank_mask:0xf bound_ctrl:0
    v_add_f32_dpp v188, v188, v188 row_shr:4 row_mask:0xf bank_mask:0xf bound_ctrl:0
    v_add_f32_dpp v189, v189, v189 row_shr:4 row_mask:0xf bank_mask:0xf bound_ctrl:0
    v_add_f32_dpp v190, v190, v190 row_shr:4 row_mask:0xf bank_mask:0xf bound_ctrl:0
    v_add_f32_dpp v182, v182, v182 row_shr:8 row_mask:0xf bank_mask:0xf bound_ctrl:0
    v_add_f32_dpp v183, v183, v183 row_shr:8 row_mask:0xf bank_mask:0xf bound_ctrl:0
    v_add_f32_dpp v184, v184, v184 row_shr:8 row_mask:0xf bank_mask:0xf bound_ctrl:0
    v_add_f32_dpp v185, v185, v185 row_shr:8 row_mask:0xf bank_mask:0xf bound_ctrl:0
    v_add_f32_dpp v186, v186, v186 row_shr:8 row_mask:0xf bank_mask:0xf bound_ctrl:0
    v_add_f32_dpp v187, v187, v187 row_shr:8 row_mask:0xf bank_mask:0xf bound_ctrl:0
    v_add_f32_dpp v188, v188, v188 row_shr:8 row_mask:0xf bank_mask:0xf bound_ctrl:0
    v_add_f32_dpp v189, v189, v189 row_shr:8 row_mask:0xf bank_mask:0xf bound_ctrl:0
    v_add_f32_dpp v190, v190, v190 row_shr:8 row_mask:0xf bank_mask:0xf bound_ctrl:0
    v_add_f32_dpp v182, v182, v182 row_bcast:15 row_mask:0xa bank_mask:0xf
    v_add_f32_dpp v183, v183, v183 row_bcast:15 row_mask:0xa bank_mask:0xf
    v_add_f32_dpp v184, v184, v184 row_bcast:15 row_mask:0xa bank_mask:0xf
    v_add_f32_dpp v185, v185, v185 row_bcast:15 row_mask:0xa bank_mask:0xf
    v_add_f32_dpp v186, v186, v186 row_bcast:15 row_mask:0xa bank_mask:0xf
    v_add_f32_dpp v187, v187, v187 row_bcast:15 row_mask:0xa bank_mask:0xf
    v_add_f32_dpp v188, v188, v188 row_bcast:15 row_mask:0xa bank_mask:0xf
    v_add_f32_dpp v189, v189, v189 row_bcast:15 row_mask:0xa bank_mask:0xf
    v_add_f32_dpp v190, v190, v190 row_bcast:15 row_mask:0xa bank_mask:0xf
    v_add_f32_dpp v182, v182, v182 row_bcast:31 row_mask:0xc bank_mask:0xf
    v_add_f32_dpp v183, v183, v183 row_bcast:31 row_mask:0xc bank_mask:0xf
    v_add_f32_dpp v184, v184, v184 row_bcast:31 row_mask:0xc bank_mask:0xf
    v_add_f32_dpp v185, v185, v185 row_bcast:31 row_mask:0xc bank_mask:0xf
    v_add_f32_dpp v186, v186, v186 row_bcast:31 row_mask:0xc bank_mask:0xf
    v_add_f32_dpp v187, v187, v187 row_bcast:31 row_mask:0xc bank_mask:0xf
    v_add_f32_dpp v188, v188, v188 row_bcast:31 row_mask:0xc bank_mask:0xf
    v_add_f32_dpp v189, v189, v189 row_bcast:31 row_mask:0xc bank_mask:0xf
    v_add_f32_dpp v190, v190, v190 row_bcast:31 row_mask:0xc bank_mask:0xf
    v_readlane_b32 s64, v182, 63
    v_readlane_b32 s65, v183, 63
    v_readlane_b32 s66, v184, 63
    v_readlane_b32 s67, v185, 63
    v_readlane_b32 s68, v186, 63
    v_writelane_b32 v44, s64, 0
    v_writelane_b32 v44, s65, 1
    v_writelane_b32 v44, s66, 2
    v_writelane_b32 v44, s67, 3
    v_writelane_b32 v44, s68, 4
    v_readlane_b32 s64, v187, 63
    v_readlane_b32 s65, v188, 63
    v_readlane_b32 s66, v189, 63
    v_readlane_b32 s67, v190, 63
    s_nop 0
    v_writelane_b32 v44, s64, 5
    v_writelane_b32 v44, s65, 6
    v_writelane_b32 v44, s66, 7
    v_writelane_b32 v44, s67, 8
    v_mov_b32 v45, s38
    s_lshl_b32 s3, s77, 2
    s_add_u32 s3, s3, s74
    s_mul_i32 s3, s3, 576
    s_add_u32 s3, s3, s75
    s_lshl_b32 s3, s3, 3
    s_add_u32 s3, s3, 720896
    v_lshlrev_b32 v4, 3, v1
    s_bfm_b64 exec, s71, 0
    buffer_store_dwordx2 v[44:45], v4, s[4:7], s3 offen sc1
    s_mov_b64 exec, -1
    s_cmp_eq_u32 s79, 2
    s_cbranch_scc1 L_W_mlpret
    s_cmp_eq_u32 s79, 3
    s_cbranch_scc1 L_C_mlp2ret
    s_branch L_C_mlpret
L_C:
    s_and_b32 s58, s72, 7
    s_lshr_b32 s56, s58, 1
    s_and_b32 s58, s58, 1
    s_lshl_b32 s58, s58, 4
    s_lshr_b32 s57, s72, 3
    s_add_u32 s57, s57, s58
    s_lshl_b32 s73, s56, 5
    s_add_u32 s73, s73, s57
    s_cmp_lt_u32 s39, 4
    s_cbranch_scc0 L_C_att
    s_mov_b32 s74, s56
    s_mul_i32 s75, s57, 18
    s_mov_b32 s71, 9
    s_mov_b32 s77, s39
    s_waitcnt lgkmcnt(0)
    s_load_dword s38, s[36:37], 0
    s_mov_b32 s4, s36
    s_and_b32 s5, s37, 0xffff
    s_mov_b32 s6, 268435456
    s_mov_b32 s7, 0x20000
    s_mov_b32 s40, s22
    s_and_b32 s41, s23, 0xffff
    s_mov_b32 s42, 9216
    s_mov_b32 s43, 0x20000
    s_mov_b32 s44, s24
    s_and_b32 s45, s25, 0xffff
    s_mov_b32 s46, 9216
    s_mov_b32 s47, 0x20000
    s_mov_b32 s48, s26
    s_and_b32 s49, s27, 0xffff
    s_mov_b32 s50, 9216
    s_mov_b32 s51, 0x20000
    s_mov_b32 s52, s8
    s_and_b32 s53, s9, 0xffff
    s_mov_b32 s54, 4608
    s_mov_b32 s55, 0x20000
    s_mul_i32 s3, s74, 1152
    v_lshlrev_b32 v4, 4, v1
    v_lshlrev_b32 v5, 2, v1
    buffer_load_dwordx4 v[222:225], v4, s[52:55], s3 offen
    buffer_load_dword v226, v5, s[52:55], s3 offen offset:1024
    s_lshl_b32 s34, s75, 1
    s_add_u32 s34, s34, s3
    v_lshlrev_b32 v6, 1, v1
    buffer_load_ushort v227, v6, s[52:55], s34 offen
    s_mul_i32 s34, s77, 2304
    buffer_load_dwordx4 v[192:195], v4, s[40:43], s34 offen
    buffer_load_dwordx4 v[196:199], v4, s[40:43], s34 offen offset:1024
    buffer_load_dword v200, v5, s[40:43], s34 offen offset:2048
    buffer_load_dwordx4 v[202:205], v4, s[44:47], s34 offen
    buffer_load_dwordx4 v[206:209], v4, s[44:47], s34 offen offset:1024
    buffer_load_dword v210, v5, s[44:47], s34 offen offset:2048
    buffer_load_dwordx4 v[212:215], v4, s[48:51], s34 offen
    buffer_load_dwordx4 v[216:219], v4, s[48:51], s34 offen offset:1024
    buffer_load_dword v220, v5, s[48:51], s34 offen offset:2048
    s_waitcnt lgkmcnt(0)
    s_add_u32 s38, s38, 1
    s_and_b32 s60, s38, 0xff
    s_bfe_u32 s61, s38, 0x80008
    s_bfe_u32 s62, s38, 0x80010
    s_lshr_b32 s63, s38, 24
    s_mov_b32 s79, 0
    s_branch L_MLP
L_C_mlpret:
    v_and_b32 v12, 3, v1
    v_lshlrev_b32 v12, 3, v12
    v_lshrrev_b32_e64 v12, v12, s38
    v_bfe_u32 v224, v12, 0, 1
    v_bfe_u32 v13, v12, 1, 1
    v_lshl_or_b32 v224, v13, 16, v224
    v_bfe_u32 v225, v12, 2, 1
    v_bfe_u32 v13, v12, 3, 1
    v_lshl_or_b32 v225, v13, 16, v225
    v_bfe_u32 v226, v12, 4, 1
    v_bfe_u32 v13, v12, 5, 1
    v_lshl_or_b32 v226, v13, 16, v226
    v_bfe_u32 v227, v12, 6, 1
    v_bfe_u32 v13, v12, 7, 1
    v_lshl_or_b32 v227, v13, 16, v227
    v_mov_b32 v228, 0xfffefffe
    v_and_b32 v6, 31, v1
    v_lshrrev_b32 v7, 5, v1
    v_lshlrev_b32 v244, 2, v6
    v_add_u32 v244, 131072, v244
    s_and_b32 s3, s39, 3
    s_lshl_b32 s58, s3, 7
    v_add_u32 v246, s58, v244
    v_lshlrev_b32 v245, 4, v1
    v_add_u32 v245, 132096, v245
    s_lshl_b32 s58, s3, 11
    v_add_u32 v247, s58, v245
    v_bfe_u32 v9, v1, 4, 1
    v_bfe_u32 v11, v1, 2, 2
    v_and_b32 v12, 3, v1
    v_lshrrev_b32 v13, 1, v12
    v_lshl_add_u32 v13, v9, 1, v13
    s_and_b32 s3, s39, 1
    s_lshl_b32 s3, s3, 3
    v_add_u32 v13, s3, v13
    v_lshlrev_b32 v14, 2, v11
    v_or_b32 v14, v14, v7
    v_lshl_add_u32 v15, v7, 2, v11
    v_lshlrev_b32 v15, 8, v15
    v_and_b32 v12, 1, v12
    v_lshl_add_u32 v15, v12, 3, v15
    s_lshr_b32 s58, s39, 1
    s_lshl_b32 s58, s58, 15
    v_add_u32 v15, s58, v15
    v_add_u32 v10, 0, v13
    v_or_b32 v12, 0, v14
    v_xor_b32 v10, v10, v12
    v_lshl_add_u32 v10, v10, 4, v15
    v_add_u32 v240, 0, v10
    v_add_u32 v10, 0, v13
    v_or_b32 v12, 2, v14
    v_xor_b32 v10, v10, v12
    v_lshl_add_u32 v10, v10, 4, v15
    v_add_u32 v241, 2048, v10
    v_add_u32 v10, 4, v13
    v_or_b32 v12, 0, v14
    v_xor_b32 v10, v10, v12
    v_lshl_add_u32 v10, v10, 4, v15
    v_add_u32 v242, 0, v10
    v_add_u32 v10, 4, v13
    v_or_b32 v12, 2, v14
    v_xor_b32 v10, v10, v12
    v_lshl_add_u32 v10, v10, 4, v15
    v_add_u32 v243, 2048, v10
    v_and_b32 v8, 3, v6
    v_lshlrev_b32 v8, 2, v8
    v_bfe_u32 v9, v6, 2, 2
    v_or_b32 v8, v8, v9
    v_xor_b32 v248, s3, v8
    v_lshl_add_u32 v9, v6, 8, s58
    v_lshl_add_u32 v249, v7, 3, v9
    v_xor_b32 v229, 0, v248
    v_lshl_add_u32 v229, v229, 4, v249
    v_xor_b32 v230, 1, v248
    v_lshl_add_u32 v230, v230, 4, v249
    v_xor_b32 v231, 2, v248
    v_lshl_add_u32 v231, v231, 4, v249
    v_xor_b32 v232, 3, v248
    v_lshl_add_u32 v232, v232, 4, v249
    v_xor_b32 v233, 4, v248
    v_lshl_add_u32 v233, v233, 4, v249
    v_xor_b32 v234, 5, v248
    v_lshl_add_u32 v234, v234, 4, v249
    v_xor_b32 v235, 6, v248
    v_lshl_add_u32 v235, v235, 4, v249
    v_xor_b32 v236, 7, v248
    v_lshl_add_u32 v236, v236, 4, v249
    v_lshrrev_b32 v6, 3, v1
    v_and_b32 v7, 7, v1
    v_lshlrev_b32 v239, 10, v6
    v_lshl_add_u32 v239, v7, 4, v239
    v_add_u32 v7, s3, v7
    v_and_b32 v12, 3, v6
    v_lshlrev_b32 v12, 2, v12
    v_lshrrev_b32 v13, 2, v6
    v_add_u32 v13, 0, v13
    v_and_b32 v13, 3, v13
    v_or_b32 v12, v12, v13
    v_xor_b32 v12, v12, v7
    v_lshlrev_b32 v12, 4, v12
    v_lshl_add_u32 v12, v6, 8, v12
    v_add_u32 v12, s58, v12
    v_add_u32 v250, 0, v12
    v_and_b32 v12, 3, v6
    v_lshlrev_b32 v12, 2, v12
    v_lshrrev_b32 v13, 2, v6
    v_add_u32 v13, 2, v13
    v_and_b32 v13, 3, v13
    v_or_b32 v12, v12, v13
    v_xor_b32 v12, v12, v7
    v_lshlrev_b32 v12, 4, v12
    v_lshl_add_u32 v12, v6, 8, v12
    v_add_u32 v12, s58, v12
    v_add_u32 v251, 2048, v12
    v_and_b32 v12, 3, v6
    v_lshlrev_b32 v12, 2, v12
    v_lshrrev_b32 v13, 2, v6
    v_add_u32 v13, 4, v13
    v_and_b32 v13, 3, v13
    v_or_b32 v12, v12, v13
    v_xor_b32 v12, v12, v7
    v_lshlrev_b32 v12, 4, v12
    v_lshl_add_u32 v12, v6, 8, v12
    v_add_u32 v12, s58, v12
    v_add_u32 v252, 4096, v12
    v_and_b32 v12, 3, v6
    v_lshlrev_b32 v12, 2, v12
    v_lshrrev_b32 v13, 2, v6
    v_add_u32 v13, 6, v13
    v_and_b32 v13, 3, v13
    v_or_b32 v12, v12, v13
    v_xor_b32 v12, v12, v7
    v_lshlrev_b32 v12, 4, v12
    v_lshl_add_u32 v12, v6, 8, v12
    v_add_u32 v12, s58, v12
    v_add_u32 v253, 6144, v12
    s_branch L_C_qkdone
L_C_att:
    s_sub_u32 s77, s39, 4
    v_lshlrev_b32 v6, 2, v3
    v_or_b32 v6, 0, v6
    v_xor_b32 v6, v6, v2
    v_lshlrev_b32 v6, 4, v6
    v_lshl_add_u32 v16, v3, 10, v6
    v_lshlrev_b32 v6, 2, v3
    v_or_b32 v6, 1, v6
    v_xor_b32 v6, v6, v2
    v_lshlrev_b32 v6, 4, v6
    v_lshl_add_u32 v17, v3, 10, v6
    v_lshlrev_b32 v6, 2, v3
    v_or_b32 v6, 2, v6
    v_xor_b32 v6, v6, v2
    v_lshlrev_b32 v6, 4, v6
    v_lshl_add_u32 v18, v3, 10, v6
    v_lshlrev_b32 v6, 2, v3
    v_or_b32 v6, 3, v6
    v_xor_b32 v6, v6, v2
    v_lshlrev_b32 v6, 4, v6
    v_lshl_add_u32 v19, v3, 10, v6
    s_waitcnt lgkmcnt(0)
    s_lshl_b32 s34, s73, 17
    s_lshl_b32 s35, s77, 15
    s_add_u32 s34, s34, s35
    s_lshl_b32 s35, s77, 13
    s_mov_b32 s59, 0
    s_load_dword s38, s[36:37], 0
    s_mov_b32 s4, s36
    s_and_b32 s5, s37, 0xffff
    s_mov_b32 s6, 268435456
    s_mov_b32 s7, 0x20000
    s_cmp_eq_u32 s77, 0
    s_cbranch_scc0 L_C_noclr
    s_lshl_b32 s3, s56, 15
    s_lshl_b32 s58, s57, 10
    s_add_u32 s3, s3, s58
    s_add_u32 s3, s3, 524288
    v_mov_b32 v44, -1
    v_mov_b32 v45, -1
    v_mov_b32 v46, -1
    v_mov_b32 v47, -1
    v_lshlrev_b32 v4, 4, v1
    buffer_store_dwordx4 v[44:47], v4, s[4:7], s3 offen sc1
L_C_noclr:
    s_mov_b32 s40, s10
    s_and_b32 s41, s11, 0xffff
    s_mov_b32 s42, 16777216
    s_mov_b32 s43, 0x20000
L_C_dma1:
    s_add_u32 s3, s34, 0
    s_add_u32 m0, s35, 0
    s_nop 0
    buffer_load_dwordx4 v16, s[40:43], s3 offen nt lds
    s_waitcnt vmcnt(8)
    s_add_u32 s3, s34, 4096
    s_add_u32 m0, s35, 1024
    s_nop 0
    buffer_load_dwordx4 v17, s[40:43], s3 offen nt lds
    s_waitcnt vmcnt(8)
    s_add_u32 s3, s34, 8192
    s_add_u32 m0, s35, 2048
    s_nop 0
    buffer_load_dwordx4 v18, s[40:43], s3 offen nt lds
    s_waitcnt vmcnt(8)
    s_add_u32 s3, s34, 12288
    s_add_u32 m0, s35, 3072
    s_nop 0
    buffer_load_dwordx4 v19, s[40:43], s3 offen nt lds
    s_waitcnt vmcnt(8)
    s_add_u32 s3, s34, 16384
    s_add_u32 m0, s35, 4096
    s_nop 0
    buffer_load_dwordx4 v16, s[40:43], s3 offen nt lds
    s_waitcnt vmcnt(8)
    s_add_u32 s3, s34, 20480
    s_add_u32 m0, s35, 5120
    s_nop 0
    buffer_load_dwordx4 v17, s[40:43], s3 offen nt lds
    s_waitcnt vmcnt(8)
    s_add_u32 s3, s34, 24576
    s_add_u32 m0, s35, 6144
    s_nop 0
    buffer_load_dwordx4 v18, s[40:43], s3 offen nt lds
    s_waitcnt vmcnt(8)
    s_add_u32 s3, s34, 28672
    s_add_u32 m0, s35, 7168
    s_nop 0
    buffer_load_dwordx4 v19, s[40:43], s3 offen nt lds
    s_waitcnt vmcnt(8)
    s_add_u32 s34, s34, 256
    s_add_u32 s35, s35, 32768
    s_add_u32 s59, s59, 1
    s_cmp_lt_u32 s59, 1
    s_cbranch_scc1 L_C_dma1
    s_cmp_eq_u32 s77, 0
    s_cbranch_scc0 L_C_noclf
    s_waitcnt vmcnt(8) lgkmcnt(0)
    s_add_u32 s58, s38, 1
    s_lshl_b32 s3, s73, 7
    s_add_u32 s3, s3, 65536
    v_mov_b32 v6, 0
    v_mov_b32 v7, s58
    s_mov_b64 exec, 1
    buffer_store_dword v7, v6, s[4:7], s3 offen sc1
    s_mov_b64 exec, -1
L_C_noclf:
L_C_dma:
    s_add_u32 s3, s34, 0
    s_add_u32 m0, s35, 0
    s_nop 0
    buffer_load_dwordx4 v16, s[40:43], s3 offen nt lds
    s_waitcnt vmcnt(8)
    s_add_u32 s3, s34, 4096
    s_add_u32 m0, s35, 1024
    s_nop 0
    buffer_load_dwordx4 v17, s[40:43], s3 offen nt lds
    s_waitcnt vmcnt(8)
    s_add_u32 s3, s34, 8192
    s_add_u32 m0, s35, 2048
    s_nop 0
    buffer_load_dwordx4 v18, s[40:43], s3 offen nt lds
    s_waitcnt vmcnt(8)
    s_add_u32 s3, s34, 12288
    s_add_u32 m0, s35, 3072
    s_nop 0
    buffer_load_dwordx4 v19, s[40:43], s3 offen nt lds
    s_waitcnt vmcnt(8)
    s_add_u32 s3, s34, 16384
    s_add_u32 m0, s35, 4096
    s_nop 0
    buffer_load_dwordx4 v16, s[40:43], s3 offen nt lds
    s_waitcnt vmcnt(8)
    s_add_u32 s3, s34, 20480
    s_add_u32 m0, s35, 5120
    s_nop 0
    buffer_load_dwordx4 v17, s[40:43], s3 offen nt lds
    s_waitcnt vmcnt(8)
    s_add_u32 s3, s34, 24576
    s_add_u32 m0, s35, 6144
    s_nop 0
    buffer_load_dwordx4 v18, s[40:43], s3 offen nt lds
    s_waitcnt vmcnt(8)
    s_add_u32 s3, s34, 28672
    s_add_u32 m0, s35, 7168
    s_nop 0
    buffer_load_dwordx4 v19, s[40:43], s3 offen nt lds
    s_waitcnt vmcnt(8)
    s_add_u32 s34, s34, 256
    s_add_u32 s35, s35, 32768
    s_add_u32 s59, s59, 1
    s_cmp_lt_u32 s59, 4
    s_cbranch_scc1 L_C_dma
    s_waitcnt lgkmcnt(0)
    s_add_u32 s38, s38, 1
    s_and_b32 s60, s38, 0xff
    s_bfe_u32 s61, s38, 0x80008
    s_bfe_u32 s62, s38, 0x80010
    s_lshr_b32 s63, s38, 24
    v_and_b32 v12, 3, v1
    v_lshlrev_b32 v12, 3, v12
    v_lshrrev_b32_e64 v12, v12, s38
    v_bfe_u32 v224, v12, 0, 1
    v_bfe_u32 v13, v12, 1, 1
    v_lshl_or_b32 v224, v13, 16, v224
    v_bfe_u32 v225, v12, 2, 1
    v_bfe_u32 v13, v12, 3, 1
    v_lshl_or_b32 v225, v13, 16, v225
    v_bfe_u32 v226, v12, 4, 1
    v_bfe_u32 v13, v12, 5, 1
    v_lshl_or_b32 v226, v13, 16, v226
    v_bfe_u32 v227, v12, 6, 1
    v_bfe_u32 v13, v12, 7, 1
    v_lshl_or_b32 v227, v13, 16, v227
    v_mov_b32 v228, 0xfffefffe
    v_and_b32 v6, 31, v1
    v_lshrrev_b32 v7, 5, v1
    v_lshlrev_b32 v244, 2, v6
    v_add_u32 v244, 131072, v244
    s_and_b32 s3, s39, 3
    s_lshl_b32 s58, s3, 7
    v_add_u32 v246, s58, v244
    v_lshlrev_b32 v245, 4, v1
    v_add_u32 v245, 132096, v245
    s_lshl_b32 s58, s3, 11
    v_add_u32 v247, s58, v245
    v_bfe_u32 v9, v1, 4, 1
    v_bfe_u32 v11, v1, 2, 2
    v_and_b32 v12, 3, v1
    v_lshrrev_b32 v13, 1, v12
    v_lshl_add_u32 v13, v9, 1, v13
    s_and_b32 s3, s39, 1
    s_lshl_b32 s3, s3, 3
    v_add_u32 v13, s3, v13
    v_lshlrev_b32 v14, 2, v11
    v_or_b32 v14, v14, v7
    v_lshl_add_u32 v15, v7, 2, v11
    v_lshlrev_b32 v15, 8, v15
    v_and_b32 v12, 1, v12
    v_lshl_add_u32 v15, v12, 3, v15
    s_lshr_b32 s58, s39, 1
    s_lshl_b32 s58, s58, 15
    v_add_u32 v15, s58, v15
    v_add_u32 v10, 0, v13
    v_or_b32 v12, 0, v14
    v_xor_b32 v10, v10, v12
    v_lshl_add_u32 v10, v10, 4, v15
    v_add_u32 v240, 0, v10
    v_add_u32 v10, 0, v13
    v_or_b32 v12, 2, v14
    v_xor_b32 v10, v10, v12
    v_lshl_add_u32 v10, v10, 4, v15
    v_add_u32 v241, 2048, v10
    v_add_u32 v10, 4, v13
    v_or_b32 v12, 0, v14
    v_xor_b32 v10, v10, v12
    v_lshl_add_u32 v10, v10, 4, v15
    v_add_u32 v242, 0, v10
    v_add_u32 v10, 4, v13
    v_or_b32 v12, 2, v14
    v_xor_b32 v10, v10, v12
    v_lshl_add_u32 v10, v10, 4, v15
    v_add_u32 v243, 2048, v10
    v_and_b32 v8, 3, v6
    v_lshlrev_b32 v8, 2, v8
    v_bfe_u32 v9, v6, 2, 2
    v_or_b32 v8, v8, v9
    v_xor_b32 v248, s3, v8
    v_lshl_add_u32 v9, v6, 8, s58
    v_lshl_add_u32 v249, v7, 3, v9
    v_xor_b32 v229, 0, v248
    v_lshl_add_u32 v229, v229, 4, v249
    v_xor_b32 v230, 1, v248
    v_lshl_add_u32 v230, v230, 4, v249
    v_xor_b32 v231, 2, v248
    v_lshl_add_u32 v231, v231, 4, v249
    v_xor_b32 v232, 3, v248
    v_lshl_add_u32 v232, v232, 4, v249
    v_xor_b32 v233, 4, v248
    v_lshl_add_u32 v233, v233, 4, v249
    v_xor_b32 v234, 5, v248
    v_lshl_add_u32 v234, v234, 4, v249
    v_xor_b32 v235, 6, v248
    v_lshl_add_u32 v235, v235, 4, v249
    v_xor_b32 v236, 7, v248
    v_lshl_add_u32 v236, v236, 4, v249
    v_lshrrev_b32 v6, 3, v1
    v_and_b32 v7, 7, v1
    v_lshlrev_b32 v239, 10, v6
    v_lshl_add_u32 v239, v7, 4, v239
    v_add_u32 v7, s3, v7
    v_and_b32 v12, 3, v6
    v_lshlrev_b32 v12, 2, v12
    v_lshrrev_b32 v13, 2, v6
    v_add_u32 v13, 0, v13
    v_and_b32 v13, 3, v13
    v_or_b32 v12, v12, v13
    v_xor_b32 v12, v12, v7
    v_lshlrev_b32 v12, 4, v12
    v_lshl_add_u32 v12, v6, 8, v12
    v_add_u32 v12, s58, v12
    v_add_u32 v250, 0, v12
    v_and_b32 v12, 3, v6
    v_lshlrev_b32 v12, 2, v12
    v_lshrrev_b32 v13, 2, v6
    v_add_u32 v13, 2, v13
    v_and_b32 v13, 3, v13
    v_or_b32 v12, v12, v13
    v_xor_b32 v12, v12, v7
    v_lshlrev_b32 v12, 4, v12
    v_lshl_add_u32 v12, v6, 8, v12
    v_add_u32 v12, s58, v12
    v_add_u32 v251, 2048, v12
    v_and_b32 v12, 3, v6
    v_lshlrev_b32 v12, 2, v12
    v_lshrrev_b32 v13, 2, v6
    v_add_u32 v13, 4, v13
    v_and_b32 v13, 3, v13
    v_or_b32 v12, v12, v13
    v_xor_b32 v12, v12, v7
    v_lshlrev_b32 v12, 4, v12
    v_lshl_add_u32 v12, v6, 8, v12
    v_add_u32 v12, s58, v12
    v_add_u32 v252, 4096, v12
    v_and_b32 v12, 3, v6
    v_lshlrev_b32 v12, 2, v12
    v_lshrrev_b32 v13, 2, v6
    v_add_u32 v13, 6, v13
    v_and_b32 v13, 3, v13
    v_or_b32 v12, v12, v13
    v_xor_b32 v12, v12, v7
    v_lshlrev_b32 v12, 4, v12
    v_lshl_add_u32 v12, v6, 8, v12
    v_add_u32 v12, s58, v12
    v_add_u32 v253, 6144, v12
    v_and_b32 v6, 31, v1
    v_lshrrev_b32 v7, 5, v1
    v_and_b32 v8, 3, v6
    v_lshlrev_b32 v8, 2, v8
    v_bfe_u32 v9, v6, 2, 2
    v_or_b32 v8, v8, v9
    v_xor_b32 v8, v8, v7
    v_lshlrev_b32 v8, 4, v8
    s_lshl_b32 s3, s77, 13
    v_lshl_add_u32 v9, v6, 8, s3
    v_and_b32 v10, 15, v6
    v_xor_b32 v10, v10, v7
    v_lshlrev_b32 v10, 4, v10
    v_lshlrev_b32 v11, 10, v6
    v_add_u32 v11, 131072, v11
    v_xor_b32 v12, 0, v8
    v_add_u32 v32, v12, v9
    v_add_u32 v40, 65536, v32
    v_xor_b32 v12, 0, v10
    v_add_u32 v48, v12, v11
    v_xor_b32 v12, 32, v8
    v_add_u32 v33, v12, v9
    v_add_u32 v41, 65536, v33
    v_xor_b32 v12, 32, v10
    v_add_u32 v49, v12, v11
    v_xor_b32 v12, 64, v8
    v_add_u32 v34, v12, v9
    v_add_u32 v42, 65536, v34
    v_xor_b32 v12, 64, v10
    v_add_u32 v50, v12, v11
    v_xor_b32 v12, 96, v8
    v_add_u32 v35, v12, v9
    v_add_u32 v43, 65536, v35
    v_xor_b32 v12, 96, v10
    v_add_u32 v51, v12, v11
    v_xor_b32 v12, 128, v8
    v_add_u32 v36, v12, v9
    v_add_u32 v44, 65536, v36
    v_xor_b32 v12, 128, v10
    v_add_u32 v52, v12, v11
    v_xor_b32 v12, 160, v8
    v_add_u32 v37, v12, v9
    v_add_u32 v45, 65536, v37
    v_xor_b32 v12, 160, v10
    v_add_u32 v53, v12, v11
    v_xor_b32 v12, 192, v8
    v_add_u32 v38, v12, v9
    v_add_u32 v46, 65536, v38
    v_xor_b32 v12, 192, v10
    v_add_u32 v54, v12, v11
    v_xor_b32 v12, 224, v8
    v_add_u32 v39, v12, v9
    v_add_u32 v47, 65536, v39
    v_xor_b32 v12, 224, v10
    v_add_u32 v55, v12, v11
    s_and_b32 s3, s77, 1
    s_lshl_b32 s3, s3, 3
    s_add_u32 s59, s3, 0
    v_xor_b32 v12, s59, v1
    v_lshlrev_b32 v20, 4, v12
    s_add_u32 s59, s3, 1
    v_xor_b32 v12, s59, v1
    v_lshlrev_b32 v21, 4, v12
    s_add_u32 s59, s3, 2
    v_xor_b32 v12, s59, v1
    v_lshlrev_b32 v22, 4, v12
    s_add_u32 s59, s3, 3
    v_xor_b32 v12, s59, v1
    v_lshlrev_b32 v23, 4, v12
    s_add_u32 s59, s3, 4
    v_xor_b32 v12, s59, v1
    v_lshlrev_b32 v24, 4, v12
    s_add_u32 s59, s3, 5
    v_xor_b32 v12, s59, v1
    v_lshlrev_b32 v25, 4, v12
    s_add_u32 s59, s3, 6
    v_xor_b32 v12, s59, v1
    v_lshlrev_b32 v26, 4, v12
    s_add_u32 s59, s3, 7
    v_xor_b32 v12, s59, v1
    v_lshlrev_b32 v27, 4, v12
    s_lshl_b32 s34, s56, 15
    s_add_u32 s34, s34, 524288
    s_lshl_b32 s3, s77, 13
    s_add_u32 s76, s34, s3
    s_add_u32 s78, s3, 131072
    s_mov_b32 s59, 0
    s_add_u32 s3, s78, 0
    v_add_u32 v208, s3, v20
    s_add_u32 s3, s78, 1024
    v_add_u32 v209, s3, v21
    s_add_u32 s3, s78, 2048
    v_add_u32 v210, s3, v22
    s_add_u32 s3, s78, 3072
    v_add_u32 v211, s3, v23
    s_add_u32 s3, s78, 4096
    v_add_u32 v212, s3, v24
    s_add_u32 s3, s78, 5120
    v_add_u32 v213, s3, v25
    s_add_u32 s3, s78, 6144
    v_add_u32 v214, s3, v26
    s_add_u32 s3, s78, 7168
    v_add_u32 v215, s3, v27
    v_and_b32 v12, 31, v1
    v_lshlrev_b32 v12, 7, v12
    s_lshl_b32 s58, s56, 12
    s_add_u32 s58, s58, 65536
L_C_clrp:
    buffer_load_dword v13, v12, s[4:7], s58 offen sc1
    s_add_u32 s59, s59, 1
    s_waitcnt vmcnt(0)
    v_cmp_eq_u32 vcc, s38, v13
    s_nop 0
    s_cmp_eq_u64 vcc, -1
    s_cbranch_scc1 L_C_clrok
    s_cmp_lt_u32 s59, 40000
    s_cbranch_scc1 L_C_clrp
L_C_clrok:
    s_mov_b32 s59, 0
    s_cmp_eq_u32 s77, 3
    s_cbranch_scc0 L_C_nogo
    s_lshl_b32 s3, s73, 7
    s_add_u32 s3, s3, 114688
    v_mov_b32 v6, 0
    v_mov_b32 v7, s38
    s_mov_b64 exec, 1
    buffer_store_dword v7, v6, s[4:7], s3 offen sc1
    s_mov_b64 exec, -1
L_C_nogo:
    s_add_u32 m0, s78, 0
    s_nop 0
    buffer_load_dwordx4 v20, s[4:7], s76 offen sc1 lds
    s_add_u32 m0, s78, 1024
    s_add_u32 s3, s76, 1024
    buffer_load_dwordx4 v21, s[4:7], s3 offen sc1 lds
    s_add_u32 m0, s78, 2048
    s_add_u32 s3, s76, 2048
    buffer_load_dwordx4 v22, s[4:7], s3 offen sc1 lds
    s_add_u32 m0, s78, 3072
    s_add_u32 s3, s76, 3072
    buffer_load_dwordx4 v23, s[4:7], s3 offen sc1 lds
    s_add_u32 m0, s78, 4096
    s_add_u32 s3, s76, 4096
    buffer_load_dwordx4 v24, s[4:7], s3 offen sc1 lds
    s_add_u32 m0, s78, 5120
    s_add_u32 s3, s76, 5120
    buffer_load_dwordx4 v25, s[4:7], s3 offen sc1 lds
    s_add_u32 m0, s78, 6144
    s_add_u32 s3, s76, 6144
    buffer_load_dwordx4 v26, s[4:7], s3 offen sc1 lds
    s_add_u32 m0, s78, 7168
    s_add_u32 s3, s76, 7168
    buffer_load_dwordx4 v27, s[4:7], s3 offen sc1 lds
    ds_read_b128 v[64:67], v32 offset:0
    ds_read_b128 v[68:71], v33 offset:0
    ds_read_b128 v[72:75], v34 offset:0
    ds_read_b128 v[76:79], v35 offset:0
    ds_read_b128 v[80:83], v36 offset:0
    ds_read_b128 v[84:87], v37 offset:0
    ds_read_b128 v[88:91], v38 offset:0
    ds_read_b128 v[92:95], v39 offset:0
    ds_read_b128 v[96:99], v32 offset:32768
    ds_read_b128 v[100:103], v33 offset:32768
    ds_read_b128 v[104:107], v34 offset:32768
    ds_read_b128 v[108:111], v35 offset:32768
    ds_read_b128 v[112:115], v36 offset:32768
    ds_read_b128 v[116:119], v37 offset:32768
    ds_read_b128 v[120:123], v38 offset:32768
    ds_read_b128 v[124:127], v39 offset:32768
    ds_read_b128 v[128:131], v40 offset:0
    ds_read_b128 v[132:135], v41 offset:0
    ds_read_b128 v[136:139], v42 offset:0
    ds_read_b128 v[140:143], v43 offset:0
    ds_read_b128 v[144:147], v44 offset:0
    ds_read_b128 v[148:151], v45 offset:0
    ds_read_b128 v[152:155], v46 offset:0
    ds_read_b128 v[156:159], v47 offset:0
    ds_read_b128 v[160:163], v40 offset:32768
    ds_read_b128 v[164:167], v41 offset:32768
    ds_read_b128 v[168:171], v42 offset:32768
    ds_read_b128 v[172:175], v43 offset:32768
    ds_read_b128 v[176:179], v44 offset:32768
    ds_read_b128 v[180:183], v45 offset:32768
    ds_read_b128 v[184:187], v46 offset:32768
    ds_read_b128 v[188:191], v47 offset:32768
L_C_val:
    s_waitcnt vmcnt(0)
    ds_read_b128 v[192:195], v208
    ds_read_b128 v[196:199], v209
    ds_read_b128 v[200:203], v210
    ds_read_b128 v[204:207], v211
    ds_read_b128 v[216:219], v212
    ds_read_b128 v[220:223], v213
    ds_read_b128 v[28:31], v214
    ds_read_b128 v[56:59], v215
    s_add_u32 s59, s59, 1
    s_waitcnt lgkmcnt(0)
    v_max3_u32 v6, v192, v193, v194
    v_max3_u32 v7, v195, v196, v197
    v_max3_u32 v6, v6, v198, v199
    v_max3_u32 v7, v7, v200, v201
    v_max3_u32 v6, v6, v202, v203
    v_max3_u32 v7, v7, v204, v205
    v_max3_u32 v6, v6, v206, v207
    v_max3_u32 v7, v7, v216, v217
    v_max3_u32 v6, v6, v218, v219
    v_max3_u32 v7, v7, v220, v221
    v_max3_u32 v6, v6, v222, v223
    v_max3_u32 v7, v7, v28, v29
    v_max3_u32 v6, v6, v30, v31
    v_max3_u32 v7, v7, v56, v57
    v_max3_u32 v6, v6, v58, v59
    v_max_u32 v6, v6, v7
    v_cmp_eq_u32 vcc, -1, v6
    s_cbranch_vccz L_C_valok
    s_cmp_lt_u32 s59, 40000
    s_cbranch_scc0 L_C_valok
    s_add_u32 m0, s78, 0
    s_nop 0
    buffer_load_dwordx4 v20, s[4:7], s76 offen sc1 lds
    s_add_u32 m0, s78, 1024
    s_add_u32 s3, s76, 1024
    buffer_load_dwordx4 v21, s[4:7], s3 offen sc1 lds
    s_add_u32 m0, s78, 2048
    s_add_u32 s3, s76, 2048
    buffer_load_dwordx4 v22, s[4:7], s3 offen sc1 lds
    s_add_u32 m0, s78, 3072
    s_add_u32 s3, s76, 3072
    buffer_load_dwordx4 v23, s[4:7], s3 offen sc1 lds
    s_add_u32 m0, s78, 4096
    s_add_u32 s3, s76, 4096
    buffer_load_dwordx4 v24, s[4:7], s3 offen sc1 lds
    s_add_u32 m0, s78, 5120
    s_add_u32 s3, s76, 5120
    buffer_load_dwordx4 v25, s[4:7], s3 offen sc1 lds
    s_add_u32 m0, s78, 6144
    s_add_u32 s3, s76, 6144
    buffer_load_dwordx4 v26, s[4:7], s3 offen sc1 lds
    s_add_u32 m0, s78, 7168
    s_add_u32 s3, s76, 7168
    buffer_load_dwordx4 v27, s[4:7], s3 offen sc1 lds
    s_branch L_C_val
L_C_valok:
L_C_qkdone:
    s_barrier
    s_cmp_lt_u32 s39, 4
    s_cbranch_scc1 L_C_sm1
    ds_read_b128 v[16:19], v48 offset:0
    ds_read_b128 v[20:23], v49 offset:0
    ds_read_b128 v[24:27], v50 offset:0
    ds_read_b128 v[28:31], v51 offset:0
    ds_read_b128 v[32:35], v52 offset:0
    ds_read_b128 v[36:39], v53 offset:0
    ds_read_b128 v[40:43], v54 offset:0
    ds_read_b128 v[44:47], v55 offset:0
    s_waitcnt lgkmcnt(4)
    v_mfma_f32_32x32x16_bf16 v[192:207], v[64:67], v[16:19], 0
    v_mfma_f32_32x32x16_bf16 v[192:207], v[68:71], v[20:23], v[192:207]
    v_mfma_f32_32x32x16_bf16 v[192:207], v[72:75], v[24:27], v[192:207]
    v_mfma_f32_32x32x16_bf16 v[192:207], v[76:79], v[28:31], v[192:207]
    ds_read_b128 v[16:19], v48 offset:256
    ds_read_b128 v[20:23], v49 offset:256
    ds_read_b128 v[24:27], v50 offset:256
    ds_read_b128 v[28:31], v51 offset:256
    s_waitcnt lgkmcnt(4)
    v_mfma_f32_32x32x16_bf16 v[192:207], v[80:83], v[32:35], v[192:207]
    v_mfma_f32_32x32x16_bf16 v[192:207], v[84:87], v[36:39], v[192:207]
    v_mfma_f32_32x32x16_bf16 v[192:207], v[88:91], v[40:43], v[192:207]
    v_mfma_f32_32x32x16_bf16 v[192:207], v[92:95], v[44:47], v[192:207]
    ds_read_b128 v[32:35], v52 offset:256
    ds_read_b128 v[36:39], v53 offset:256
    ds_read_b128 v[40:43], v54 offset:256
    ds_read_b128 v[44:47], v55 offset:256
    s_waitcnt lgkmcnt(4)
    v_mfma_f32_32x32x16_bf16 v[192:207], v[96:99], v[16:19], v[192:207]
    v_mfma_f32_32x32x16_bf16 v[192:207], v[100:103], v[20:23], v[192:207]
    v_mfma_f32_32x32x16_bf16 v[192:207], v[104:107], v[24:27], v[192:207]
    v_mfma_f32_32x32x16_bf16 v[192:207], v[108:111], v[28:31], v[192:207]
    ds_read_b128 v[16:19], v48 offset:512
    ds_read_b128 v[20:23], v49 offset:512
    ds_read_b128 v[24:27], v50 offset:512
    ds_read_b128 v[28:31], v51 offset:512
    s_waitcnt lgkmcnt(4)
    v_mfma_f32_32x32x16_bf16 v[192:207], v[112:115], v[32:35], v[192:207]
    v_mfma_f32_32x32x16_bf16 v[192:207], v[116:119], v[36:39], v[192:207]
    v_mfma_f32_32x32x16_bf16 v[192:207], v[120:123], v[40:43], v[192:207]
    v_mfma_f32_32x32x16_bf16 v[192:207], v[124:127], v[44:47], v[192:207]
    ds_read_b128 v[32:35], v52 offset:512
    ds_read_b128 v[36:39], v53 offset:512
    ds_read_b128 v[40:43], v54 offset:512
    ds_read_b128 v[44:47], v55 offset:512
    s_waitcnt lgkmcnt(4)
    v_mfma_f32_32x32x16_bf16 v[192:207], v[128:131], v[16:19], v[192:207]
    v_mfma_f32_32x32x16_bf16 v[192:207], v[132:135], v[20:23], v[192:207]
    v_mfma_f32_32x32x16_bf16 v[192:207], v[136:139], v[24:27], v[192:207]
    v_mfma_f32_32x32x16_bf16 v[192:207], v[140:143], v[28:31], v[192:207]
    ds_read_b128 v[16:19], v48 offset:768
    ds_read_b128 v[20:23], v49 offset:768
    ds_read_b128 v[24:27], v50 offset:768
    ds_read_b128 v[28:31], v51 offset:768
    s_waitcnt lgkmcnt(4)
    v_mfma_f32_32x32x16_bf16 v[192:207], v[144:147], v[32:35], v[192:207]
    v_mfma_f32_32x32x16_bf16 v[192:207], v[148:151], v[36:39], v[192:207]
    v_mfma_f32_32x32x16_bf16 v[192:207], v[152:155], v[40:43], v[192:207]
    v_mfma_f32_32x32x16_bf16 v[192:207], v[156:159], v[44:47], v[192:207]
    ds_read_b128 v[32:35], v52 offset:768
    ds_read_b128 v[36:39], v53 offset:768
    ds_read_b128 v[40:43], v54 offset:768
    ds_read_b128 v[44:47], v55 offset:768
    s_waitcnt lgkmcnt(4)
    v_mfma_f32_32x32x16_bf16 v[192:207], v[160:163], v[16:19], v[192:207]
    v_mfma_f32_32x32x16_bf16 v[192:207], v[164:167], v[20:23], v[192:207]
    v_mfma_f32_32x32x16_bf16 v[192:207], v[168:171], v[24:27], v[192:207]
    v_mfma_f32_32x32x16_bf16 v[192:207], v[172:175], v[28:31], v[192:207]
    s_waitcnt lgkmcnt(0)
    v_mfma_f32_32x32x16_bf16 v[192:207], v[176:179], v[32:35], v[192:207]
    v_mfma_f32_32x32x16_bf16 v[192:207], v[180:183], v[36:39], v[192:207]
    v_mfma_f32_32x32x16_bf16 v[192:207], v[184:187], v[40:43], v[192:207]
    v_mfma_f32_32x32x16_bf16 v[192:207], v[188:191], v[44:47], v[192:207]
    s_nop 11
    v_max3_f32 v60, v192, v193, v194
    v_max3_f32 v61, v195, v196, v197
    v_max3_f32 v62, v198, v199, v200
    v_max3_f32 v63, v201, v202, v203
    v_max3_f32 v60, v60, v204, v205
    v_max3_f32 v61, v61, v206, v207
    v_max3_f32 v60, v60, v62, v63
    v_max_f32 v60, v60, v61
    v_mov_b32 v61, v60
    s_nop 1
    v_permlane32_swap_b32 v60, v61
    v_max_f32 v60, v60, v61
L_C_sm1:
    s_barrier
    s_cmp_lt_u32 s39, 4
    s_cbranch_scc1 L_C_sm2
    s_mov_b64 exec, 0xffffffff
    ds_write_b32 v246, v60
    s_mov_b64 exec, -1
    s_waitcnt lgkmcnt(0)
L_C_sm2:
    s_barrier
    s_cmp_lt_u32 s39, 4
    s_cbranch_scc1 L_C_sm3
    ds_read_b32 v60, v244
    ds_read_b32 v61, v244 offset:128
    ds_read_b32 v62, v244 offset:256
    ds_read_b32 v63, v244 offset:384
    s_waitcnt lgkmcnt(0)
    v_max3_f32 v60, v60, v61, v62
    v_max_f32 v60, v60, v63
    v_mov_b32 v62, 0x3e0293ee
    v_mov_b32 v63, 0x3e0293ee
    v_mul_f32 v60, v62, v60
    v_mov_b32 v61, v60
    v_pk_fma_f32 v[192:193], v[192:193], v[62:63], v[60:61] neg_lo:[0,0,1] neg_hi:[0,0,1]
    v_pk_fma_f32 v[194:195], v[194:195], v[62:63], v[60:61] neg_lo:[0,0,1] neg_hi:[0,0,1]
    v_pk_fma_f32 v[196:197], v[196:197], v[62:63], v[60:61] neg_lo:[0,0,1] neg_hi:[0,0,1]
    v_pk_fma_f32 v[198:199], v[198:199], v[62:63], v[60:61] neg_lo:[0,0,1] neg_hi:[0,0,1]
    v_pk_fma_f32 v[200:201], v[200:201], v[62:63], v[60:61] neg_lo:[0,0,1] neg_hi:[0,0,1]
    v_pk_fma_f32 v[202:203], v[202:203], v[62:63], v[60:61] neg_lo:[0,0,1] neg_hi:[0,0,1]
    v_pk_fma_f32 v[204:205], v[204:205], v[62:63], v[60:61] neg_lo:[0,0,1] neg_hi:[0,0,1]
    v_pk_fma_f32 v[206:207], v[206:207], v[62:63], v[60:61] neg_lo:[0,0,1] neg_hi:[0,0,1]
    v_exp_f32 v192, v192
    v_exp_f32 v193, v193
    v_exp_f32 v194, v194
    v_exp_f32 v195, v195
    v_exp_f32 v196, v196
    v_exp_f32 v197, v197
    v_exp_f32 v198, v198
    v_exp_f32 v199, v199
    v_exp_f32 v200, v200
    v_exp_f32 v201, v201
    v_exp_f32 v202, v202
    v_exp_f32 v203, v203
    v_exp_f32 v204, v204
    v_exp_f32 v205, v205
    v_exp_f32 v206, v206
    v_exp_f32 v207, v207
    v_cvt_pk_bf16_f32 v64, v192, v193
    v_cvt_pk_bf16_f32 v65, v194, v195
    v_cvt_pk_bf16_f32 v66, v196, v197
    v_cvt_pk_bf16_f32 v67, v198, v199
    v_cvt_pk_bf16_f32 v68, v200, v201
    v_cvt_pk_bf16_f32 v69, v202, v203
    v_cvt_pk_bf16_f32 v70, v204, v205
    v_cvt_pk_bf16_f32 v71, v206, v207
    ds_write_b128 v247, v[64:67]
    ds_write_b128 v247, v[68:71] offset:1024
    v_pk_add_f32 v[192:193], v[192:193], v[200:201]
    v_pk_add_f32 v[194:195], v[194:195], v[202:203]
    v_pk_add_f32 v[196:197], v[196:197], v[204:205]
    v_pk_add_f32 v[198:199], v[198:199], v[206:207]
    v_pk_add_f32 v[192:193], v[192:193], v[196:197]
    v_pk_add_f32 v[194:195], v[194:195], v[198:199]
    v_pk_add_f32 v[192:193], v[192:193], v[194:195]
    v_add_f32 v192, v192, v193
    v_mov_b32 v62, v192
    s_nop 1
    v_permlane32_swap_b32 v192, v62
    v_add_f32 v192, v192, v62
    s_mov_b64 exec, 0xffffffff
    ds_write_b32 v246, v192 offset:512
    s_mov_b64 exec, -1
L_C_sm3:
    ds_read_b64_tr_b16 v[96:97], v240 offset:0
    ds_read_b64_tr_b16 v[98:99], v241 offset:0
    ds_read_b64_tr_b16 v[100:101], v242 offset:0
    ds_read_b64_tr_b16 v[102:103], v243 offset:0
    ds_read_b64_tr_b16 v[104:105], v240 offset:4096
    ds_read_b64_tr_b16 v[106:107], v241 offset:4096
    ds_read_b64_tr_b16 v[108:109], v242 offset:4096
    ds_read_b64_tr_b16 v[110:111], v243 offset:4096
    s_waitcnt lgkmcnt(8)
    s_barrier
    ds_read_b128 v[64:67], v245 offset:0
    ds_read_b128 v[68:71], v245 offset:1024
    ds_read_b128 v[72:75], v245 offset:2048
    ds_read_b128 v[76:79], v245 offset:3072
    ds_read_b128 v[80:83], v245 offset:4096
    ds_read_b128 v[84:87], v245 offset:5120
    ds_read_b128 v[88:91], v245 offset:6144
    ds_read_b128 v[92:95], v245 offset:7168
    ds_read_b64_tr_b16 v[112:113], v240 offset:8192
    ds_read_b64_tr_b16 v[114:115], v241 offset:8192
    ds_read_b64_tr_b16 v[116:117], v242 offset:8192
    ds_read_b64_tr_b16 v[118:119], v243 offset:8192
    s_waitcnt lgkmcnt(11)
    v_mfma_f32_32x32x16_bf16 v[128:143], v[96:99], v[64:67], 0
    v_mfma_f32_32x32x16_bf16 v[144:159], v[100:103], v[64:67], 0
    ds_read_b64_tr_b16 v[96:97], v240 offset:12288
    ds_read_b64_tr_b16 v[98:99], v241 offset:12288
    ds_read_b64_tr_b16 v[100:101], v242 offset:12288
    ds_read_b64_tr_b16 v[102:103], v243 offset:12288
    s_waitcnt lgkmcnt(12)
    v_mfma_f32_32x32x16_bf16 v[128:143], v[104:107], v[68:71], v[128:143]
    v_mfma_f32_32x32x16_bf16 v[144:159], v[108:111], v[68:71], v[144:159]
    ds_read_b64_tr_b16 v[104:105], v240 offset:16384
    ds_read_b64_tr_b16 v[106:107], v241 offset:16384
    ds_read_b64_tr_b16 v[108:109], v242 offset:16384
    ds_read_b64_tr_b16 v[110:111], v243 offset:16384
    s_waitcnt lgkmcnt(8)
    v_mfma_f32_32x32x16_bf16 v[128:143], v[112:115], v[72:75], v[128:143]
    v_mfma_f32_32x32x16_bf16 v[144:159], v[116:119], v[72:75], v[144:159]
    ds_read_b64_tr_b16 v[112:113], v240 offset:20480
    ds_read_b64_tr_b16 v[114:115], v241 offset:20480
    ds_read_b64_tr_b16 v[116:117], v242 offset:20480
    ds_read_b64_tr_b16 v[118:119], v243 offset:20480
    s_waitcnt lgkmcnt(8)
    v_mfma_f32_32x32x16_bf16 v[128:143], v[96:99], v[76:79], v[128:143]
    v_mfma_f32_32x32x16_bf16 v[144:159], v[100:103], v[76:79], v[144:159]
    ds_read_b64_tr_b16 v[96:97], v240 offset:24576
    ds_read_b64_tr_b16 v[98:99], v241 offset:24576
    ds_read_b64_tr_b16 v[100:101], v242 offset:24576
    ds_read_b64_tr_b16 v[102:103], v243 offset:24576
    s_waitcnt lgkmcnt(8)
    v_mfma_f32_32x32x16_bf16 v[128:143], v[104:107], v[80:83], v[128:143]
    v_mfma_f32_32x32x16_bf16 v[144:159], v[108:111], v[80:83], v[144:159]
    ds_read_b64_tr_b16 v[104:105], v240 offset:28672
    ds_read_b64_tr_b16 v[106:107], v241 offset:28672
    ds_read_b64_tr_b16 v[108:109], v242 offset:28672
    ds_read_b64_tr_b16 v[110:111], v243 offset:28672
    s_waitcnt lgkmcnt(8)
    v_mfma_f32_32x32x16_bf16 v[128:143], v[112:115], v[84:87], v[128:143]
    v_mfma_f32_32x32x16_bf16 v[144:159], v[116:119], v[84:87], v[144:159]
    ds_read_b32 v60, v244 offset:0
    ds_read_b32 v56, v244 offset:512
    ds_read_b32 v61, v244 offset:128
    ds_read_b32 v57, v244 offset:640
    ds_read_b32 v62, v244 offset:256
    ds_read_b32 v58, v244 offset:768
    ds_read_b32 v63, v244 offset:384
    ds_read_b32 v59, v244 offset:896
    s_waitcnt lgkmcnt(12)
    v_mfma_f32_32x32x16_bf16 v[128:143], v[96:99], v[88:91], v[128:143]
    v_mfma_f32_32x32x16_bf16 v[144:159], v[100:103], v[88:91], v[144:159]
    s_waitcnt lgkmcnt(8)
    v_mfma_f32_32x32x16_bf16 v[128:143], v[104:107], v[92:95], v[128:143]
    v_mfma_f32_32x32x16_bf16 v[144:159], v[108:111], v[92:95], v[144:159]
    s_waitcnt lgkmcnt(0)
    s_cmp_eq_u32 s39, 0
    s_cbranch_scc0 L_C_noml
    v_max3_f32 v60, v60, v61, v62
    v_max_f32 v60, v60, v63
    v_mul_f32 v60, 0x3e0293ee, v60
    v_add_f32 v56, v56, v57
    v_add_f32 v58, v58, v59
    v_add_f32 v61, v56, v58
    v_mov_b32 v62, s38
    v_mov_b32 v63, s38
    v_and_b32 v6, 31, v1
    v_lshlrev_b32 v10, 11, v6
    s_lshl_b32 s3, s73, 4
    s_add_u32 s3, s3, 13631488
    s_mov_b64 exec, 0xffffffff
    buffer_store_dwordx4 v[60:63], v10, s[4:7], s3 offen sc1
    s_mov_b64 exec, -1
L_C_noml:
    s_lshl_b32 s35, s73, 15
    s_add_u32 s35, s35, 1048576
    s_lshl_b32 s58, s39, 7
    s_add_u32 s35, s35, s58
    v_cvt_pk_bf16_f32 v64, v128, v129
    v_cvt_pk_bf16_f32 v65, v130, v131
    ds_write_b64 v229, v[64:65]
    v_cvt_pk_bf16_f32 v66, v132, v133
    v_cvt_pk_bf16_f32 v67, v134, v135
    ds_write_b64 v230, v[66:67]
    v_cvt_pk_bf16_f32 v68, v136, v137
    v_cvt_pk_bf16_f32 v69, v138, v139
    ds_write_b64 v231, v[68:69]
    v_cvt_pk_bf16_f32 v70, v140, v141
    v_cvt_pk_bf16_f32 v71, v142, v143
    ds_write_b64 v232, v[70:71]
    v_cvt_pk_bf16_f32 v72, v144, v145
    v_cvt_pk_bf16_f32 v73, v146, v147
    ds_write_b64 v233, v[72:73]
    v_cvt_pk_bf16_f32 v74, v148, v149
    v_cvt_pk_bf16_f32 v75, v150, v151
    ds_write_b64 v234, v[74:75]
    v_cvt_pk_bf16_f32 v76, v152, v153
    v_cvt_pk_bf16_f32 v77, v154, v155
    ds_write_b64 v235, v[76:77]
    v_cvt_pk_bf16_f32 v78, v156, v157
    v_cvt_pk_bf16_f32 v79, v158, v159
    ds_write_b64 v236, v[78:79]
    s_waitcnt lgkmcnt(0)
    ds_read_b128 v[32:35], v250
    ds_read_b128 v[36:39], v251
    ds_read_b128 v[40:43], v252
    ds_read_b128 v[44:47], v253
    s_waitcnt lgkmcnt(3)
    v_and_or_b32 v32, v32, v228, v224
    v_and_or_b32 v33, v33, v228, v225
    v_and_or_b32 v34, v34, v228, v226
    v_and_or_b32 v35, v35, v228, v227
    buffer_store_dwordx4 v[32:35], v239, s[4:7], s35 offen sc1
    s_add_u32 s35, s35, 8192
    s_waitcnt lgkmcnt(2)
    v_and_or_b32 v36, v36, v228, v224
    v_and_or_b32 v37, v37, v228, v225
    v_and_or_b32 v38, v38, v228, v226
    v_and_or_b32 v39, v39, v228, v227
    buffer_store_dwordx4 v[36:39], v239, s[4:7], s35 offen sc1
    s_add_u32 s35, s35, 8192
    s_waitcnt lgkmcnt(1)
    v_and_or_b32 v40, v40, v228, v224
    v_and_or_b32 v41, v41, v228, v225
    v_and_or_b32 v42, v42, v228, v226
    v_and_or_b32 v43, v43, v228, v227
    buffer_store_dwordx4 v[40:43], v239, s[4:7], s35 offen sc1
    s_add_u32 s35, s35, 8192
    s_waitcnt lgkmcnt(0)
    v_and_or_b32 v44, v44, v228, v224
    v_and_or_b32 v45, v45, v228, v225
    v_and_or_b32 v46, v46, v228, v226
    v_and_or_b32 v47, v47, v228, v227
    buffer_store_dwordx4 v[44:47], v239, s[4:7], s35 offen sc1
    s_barrier
L_C_mlp2ret:
    s_cmp_lt_u32 s73, 72
    s_cbranch_scc0 L_fin
    v_mov_b32 v31, 0
    s_cmp_eq_u32 s39, 0
    s_cbranch_scc0 L_C_f0
    s_mov_b32 s44, s8
    s_and_b32 s45, s9, 0xffff
    s_mov_b32 s46, 4608
    s_mov_b32 s47, 0x20000
    s_mov_b32 s48, s30
    s_and_b32 s49, s31, 0xffff
    s_mov_b32 s50, 1152
    s_mov_b32 s51, 0x20000
    s_mov_b32 s40, s28
    s_and_b32 s41, s29, 0xffff
    s_mov_b32 s42, 2
    s_mov_b32 s43, 0x20000
    v_lshlrev_b32 v4, 4, v1
    v_lshlrev_b32 v5, 2, v1
    buffer_load_dwordx4 v[16:19], v4, s[48:51], 0 offen
    buffer_load_dword v20, v5, s[48:51], 0 offen offset:1024
    s_mov_b32 s3, 0
    buffer_load_dwordx4 v[24:27], v4, s[44:47], s3 offen
    buffer_load_dword v28, v5, s[44:47], s3 offen offset:1024
    s_mov_b32 s3, 1152
    buffer_load_dwordx4 v[32:35], v4, s[44:47], s3 offen
    buffer_load_dword v36, v5, s[44:47], s3 offen offset:1024
    s_mov_b32 s3, 2304
    buffer_load_dwordx4 v[40:43], v4, s[44:47], s3 offen
    buffer_load_dword v44, v5, s[44:47], s3 offen offset:1024
    s_mov_b32 s3, 3456
    buffer_load_dwordx4 v[48:51], v4, s[44:47], s3 offen
    buffer_load_dword v52, v5, s[44:47], s3 offen offset:1024
    v_mov_b32 v60, 0
    buffer_load_ushort v61, v60, s[40:43], 0 offen
    v_cmp_gt_u32 vcc, 32, v1
    s_waitcnt vmcnt(0)
    s_nop 0
    v_cndmask_b32 v20, 0, v20, vcc
    v_lshlrev_b32 v64, 16, v16
    v_and_b32 v65, 0xffff0000, v16
    v_lshlrev_b32 v66, 16, v17
    v_and_b32 v67, 0xffff0000, v17
    v_lshlrev_b32 v68, 16, v18
    v_and_b32 v69, 0xffff0000, v18
    v_lshlrev_b32 v70, 16, v19
    v_and_b32 v71, 0xffff0000, v19
    v_lshlrev_b32 v72, 16, v20
    v_and_b32 v73, 0xffff0000, v20
    v_lshlrev_b32 v74, 16, v24
    v_and_b32 v75, 0xffff0000, v24
    v_mul_f32 v76, v74, v64
    v_fmac_f32 v76, v75, v65
    v_lshlrev_b32 v74, 16, v25
    v_and_b32 v75, 0xffff0000, v25
    v_fmac_f32 v76, v74, v66
    v_fmac_f32 v76, v75, v67
    v_lshlrev_b32 v74, 16, v26
    v_and_b32 v75, 0xffff0000, v26
    v_fmac_f32 v76, v74, v68
    v_fmac_f32 v76, v75, v69
    v_lshlrev_b32 v74, 16, v27
    v_and_b32 v75, 0xffff0000, v27
    v_fmac_f32 v76, v74, v70
    v_fmac_f32 v76, v75, v71
    v_lshlrev_b32 v74, 16, v28
    v_and_b32 v75, 0xffff0000, v28
    v_fmac_f32 v76, v74, v72
    v_fmac_f32 v76, v75, v73
    v_lshlrev_b32 v74, 16, v32
    v_and_b32 v75, 0xffff0000, v32
    v_mul_f32 v77, v74, v64
    v_fmac_f32 v77, v75, v65
    v_lshlrev_b32 v74, 16, v33
    v_and_b32 v75, 0xffff0000, v33
    v_fmac_f32 v77, v74, v66
    v_fmac_f32 v77, v75, v67
    v_lshlrev_b32 v74, 16, v34
    v_and_b32 v75, 0xffff0000, v34
    v_fmac_f32 v77, v74, v68
    v_fmac_f32 v77, v75, v69
    v_lshlrev_b32 v74, 16, v35
    v_and_b32 v75, 0xffff0000, v35
    v_fmac_f32 v77, v74, v70
    v_fmac_f32 v77, v75, v71
    v_lshlrev_b32 v74, 16, v36
    v_and_b32 v75, 0xffff0000, v36
    v_fmac_f32 v77, v74, v72
    v_fmac_f32 v77, v75, v73
    v_lshlrev_b32 v74, 16, v40
    v_and_b32 v75, 0xffff0000, v40
    v_mul_f32 v78, v74, v64
    v_fmac_f32 v78, v75, v65
    v_lshlrev_b32 v74, 16, v41
    v_and_b32 v75, 0xffff0000, v41
    v_fmac_f32 v78, v74, v66
    v_fmac_f32 v78, v75, v67
    v_lshlrev_b32 v74, 16, v42
    v_and_b32 v75, 0xffff0000, v42
    v_fmac_f32 v78, v74, v68
    v_fmac_f32 v78, v75, v69
    v_lshlrev_b32 v74, 16, v43
    v_and_b32 v75, 0xffff0000, v43
    v_fmac_f32 v78, v74, v70
    v_fmac_f32 v78, v75, v71
    v_lshlrev_b32 v74, 16, v44
    v_and_b32 v75, 0xffff0000, v44
    v_fmac_f32 v78, v74, v72
    v_fmac_f32 v78, v75, v73
    v_lshlrev_b32 v74, 16, v48
    v_and_b32 v75, 0xffff0000, v48
    v_mul_f32 v79, v74, v64
    v_fmac_f32 v79, v75, v65
    v_lshlrev_b32 v74, 16, v49
    v_and_b32 v75, 0xffff0000, v49
    v_fmac_f32 v79, v74, v66
    v_fmac_f32 v79, v75, v67
    v_lshlrev_b32 v74, 16, v50
    v_and_b32 v75, 0xffff0000, v50
    v_fmac_f32 v79, v74, v68
    v_fmac_f32 v79, v75, v69
    v_lshlrev_b32 v74, 16, v51
    v_and_b32 v75, 0xffff0000, v51
    v_fmac_f32 v79, v74, v70
    v_fmac_f32 v79, v75, v71
    v_lshlrev_b32 v74, 16, v52
    v_and_b32 v75, 0xffff0000, v52
    v_fmac_f32 v79, v74, v72
    v_fmac_f32 v79, v75, v73
    v_add_f32_dpp v76, v76, v76 row_shr:1 row_mask:0xf bank_mask:0xf bound_ctrl:0
    v_add_f32_dpp v77, v77, v77 row_shr:1 row_mask:0xf bank_mask:0xf bound_ctrl:0
    v_add_f32_dpp v78, v78, v78 row_shr:1 row_mask:0xf bank_mask:0xf bound_ctrl:0
    v_add_f32_dpp v79, v79, v79 row_shr:1 row_mask:0xf bank_mask:0xf bound_ctrl:0
    v_add_f32_dpp v76, v76, v76 row_shr:2 row_mask:0xf bank_mask:0xf bound_ctrl:0
    v_add_f32_dpp v77, v77, v77 row_shr:2 row_mask:0xf bank_mask:0xf bound_ctrl:0
    v_add_f32_dpp v78, v78, v78 row_shr:2 row_mask:0xf bank_mask:0xf bound_ctrl:0
    v_add_f32_dpp v79, v79, v79 row_shr:2 row_mask:0xf bank_mask:0xf bound_ctrl:0
    v_add_f32_dpp v76, v76, v76 row_shr:4 row_mask:0xf bank_mask:0xf bound_ctrl:0
    v_add_f32_dpp v77, v77, v77 row_shr:4 row_mask:0xf bank_mask:0xf bound_ctrl:0
    v_add_f32_dpp v78, v78, v78 row_shr:4 row_mask:0xf bank_mask:0xf bound_ctrl:0
    v_add_f32_dpp v79, v79, v79 row_shr:4 row_mask:0xf bank_mask:0xf bound_ctrl:0
    v_add_f32_dpp v76, v76, v76 row_shr:8 row_mask:0xf bank_mask:0xf bound_ctrl:0
    v_add_f32_dpp v77, v77, v77 row_shr:8 row_mask:0xf bank_mask:0xf bound_ctrl:0
    v_add_f32_dpp v78, v78, v78 row_shr:8 row_mask:0xf bank_mask:0xf bound_ctrl:0
    v_add_f32_dpp v79, v79, v79 row_shr:8 row_mask:0xf bank_mask:0xf bound_ctrl:0
    v_add_f32_dpp v76, v76, v76 row_bcast:15 row_mask:0xa bank_mask:0xf
    v_add_f32_dpp v77, v77, v77 row_bcast:15 row_mask:0xa bank_mask:0xf
    v_add_f32_dpp v78, v78, v78 row_bcast:15 row_mask:0xa bank_mask:0xf
    v_add_f32_dpp v79, v79, v79 row_bcast:15 row_mask:0xa bank_mask:0xf
    v_add_f32_dpp v76, v76, v76 row_bcast:31 row_mask:0xc bank_mask:0xf
    v_add_f32_dpp v77, v77, v77 row_bcast:31 row_mask:0xc bank_mask:0xf
    v_add_f32_dpp v78, v78, v78 row_bcast:31 row_mask:0xc bank_mask:0xf
    v_add_f32_dpp v79, v79, v79 row_bcast:31 row_mask:0xc bank_mask:0xf
    v_readlane_b32 s64, v76, 63
    v_readlane_b32 s65, v77, 63
    v_readlane_b32 s66, v78, 63
    v_readlane_b32 s67, v79, 63
    v_lshrrev_b32 v6, 3, v1
    v_mov_b32 v62, s64
    v_mov_b32 v63, s65
    v_cmp_eq_u32 vcc, 1, v6
    s_nop 1
    v_cndmask_b32 v62, v62, v63, vcc
    v_mov_b32 v63, s66
    v_cmp_eq_u32 vcc, 2, v6
    s_nop 1
    v_cndmask_b32 v62, v62, v63, vcc
    v_mov_b32 v63, s67
    v_cmp_eq_u32 vcc, 3, v6
    s_nop 1
    v_cndmask_b32 v62, v62, v63, vcc
    v_mul_f32 v62, 0xbfb8aa3b, v62
    v_exp_f32 v62, v62
    s_nop 0
    v_add_f32 v62, 1.0, v62
    v_rcp_f32 v62, v62
    v_lshlrev_b32 v61, 16, v61
    v_and_b32 v7, 7, v1
    s_movk_i32 s3, 576
    v_mad_u32_u24 v7, v6, s3, v7
    v_lshlrev_b32 v7, 3, v7
    s_lshl_b32 s35, s73, 6
    s_add_u32 s35, s35, 720896
    s_mov_b32 s59, 0
    s_mov_b64 s[78:79], 0xffffffff
L_C_py:
    s_add_u32 s3, s35, 0
    buffer_load_dwordx2 v[64:65], v7, s[4:7], s3 offen sc1
    s_add_u32 s3, s35, 18432
    buffer_load_dwordx2 v[66:67], v7, s[4:7], s3 offen sc1
    s_add_u32 s3, s35, 36864
    buffer_load_dwordx2 v[68:69], v7, s[4:7], s3 offen sc1
    s_add_u32 s3, s35, 55296
    buffer_load_dwordx2 v[70:71], v7, s[4:7], s3 offen sc1
    s_add_u32 s59, s59, 1
    s_waitcnt vmcnt(0)
    v_cmp_eq_u32 vcc, s38, v65
    v_cmp_eq_u32 s[20:21], s38, v67
    s_nop 0
    s_and_b64 vcc, vcc, s[20:21]
    v_cmp_eq_u32 s[20:21], s38, v69
    s_nop 0
    s_and_b64 vcc, vcc, s[20:21]
    v_cmp_eq_u32 s[20:21], s38, v71
    s_nop 0
    s_and_b64 vcc, vcc, s[20:21]
    s_orn2_b64 vcc, vcc, s[78:79]
    s_cmp_eq_u64 vcc, -1
    s_cbranch_scc1 L_C_pyok
    s_cmp_lt_u32 s59, 40000
    s_cbranch_scc1 L_C_py
L_C_pyok:
    v_add_f32 v64, v64, v66
    v_add_f32 v68, v68, v70
    v_add_f32 v64, v64, v68
    v_add_f32 v61, v61, v64
    v_and_b32 v30, 7, v1
    v_lshlrev_b32 v30, 4, v30
    v_lshrrev_b32 v31, 3, v1
    v_and_b32 v31, 3, v31
    v_lshl_add_u32 v30, v31, 2, v30
    s_movk_i32 s3, 1152
    v_lshrrev_b32 v31, 3, v1
    v_mul_u32_u24 v31, s3, v31
    v_and_b32 v32, 7, v1
    v_lshl_add_u32 v31, v32, 1, v31
    v_and_b32 v4, 7, v1
    s_mov_b32 s3, 147456
    v_mul_lo_u32 v4, v4, s3
    s_lshl_b32 s34, s73, 7
    s_add_u32 s34, s34, 6291456
    v_mov_b32 v12, 0x0c0c0400
    s_mov_b32 s59, 0
L_C_h5:
    buffer_load_dwordx4 v[16:19], v4, s[4:7], s34 offen sc1
    s_add_u32 s59, s59, 1
    s_waitcnt vmcnt(0)
    v_xor_b32 v16, s60, v16
    v_xor_b32 v17, s61, v17
    v_xor_b32 v18, s62, v18
    v_xor_b32 v19, s63, v19
    v_or3_b32 v13, v16, v17, v18
    v_or_b32 v13, v13, v19
    v_and_b32 v13, 0xff, v13
    v_cmp_eq_u32 vcc, 0, v13
    s_cbranch_vccnz L_C_f0
    s_sleep 1
    s_cmp_lt_u32 s59, 40000
    s_cbranch_scc1 L_C_h5
L_C_f0:
    s_barrier
    s_mov_b32 s44, s32
    s_and_b32 s45, s33, 0xffff
    s_mov_b32 s46, 4608
    s_mov_b32 s47, 0x20000
    v_lshrrev_b32 v4, 3, v0
    v_and_b32 v5, 7, v0
    s_movk_i32 s3, 9216
    v_mul_lo_u32 v4, v4, s3
    v_lshl_add_u32 v4, v5, 4, v4
    s_lshl_b32 s34, s73, 7
    s_add_u32 s34, s34, 6291456
    s_add_u32 s35, s34, 589824
    v_mov_b32 v12, 0x0c0c0400
    v_lshlrev_b32 v10, 4, v1
    s_lshl_b32 s3, s39, 7
    v_add_u32 v10, s3, v10
    s_mov_b32 s59, 0
L_C_p5:
    buffer_load_dwordx4 v[16:19], v4, s[4:7], s34 offen sc1
    buffer_load_dwordx4 v[20:23], v4, s[4:7], s35 offen sc1
    s_add_u32 s59, s59, 1
    s_waitcnt vmcnt(0)
    v_xor_b32 v16, s60, v16
    v_xor_b32 v17, s61, v17
    v_xor_b32 v18, s62, v18
    v_xor_b32 v19, s63, v19
    v_or3_b32 v13, v16, v17, v18
    v_or_b32 v13, v13, v19
    v_xor_b32 v20, s60, v20
    v_xor_b32 v21, s61, v21
    v_xor_b32 v22, s62, v22
    v_xor_b32 v23, s63, v23
    v_or3_b32 v13, v13, v20, v21
    v_or3_b32 v13, v13, v22, v23
    v_and_b32 v13, 0xff, v13
    v_cmp_eq_u32 vcc, 0, v13
    s_nop 0
    s_cmp_eq_u64 vcc, -1
    s_cbranch_scc1 L_C_p5ok
    s_cmp_lt_u32 s59, 40000
    s_cbranch_scc1 L_C_p5
L_C_p5ok:
    v_pk_add_f32 v[16:17], v[16:17], v[20:21]
    v_pk_add_f32 v[18:19], v[18:19], v[22:23]
    s_nop 0
    v_add_f32_dpp v16, v16, v16 row_ror:8 row_mask:0xf bank_mask:0xf
    v_add_f32_dpp v17, v17, v17 row_ror:8 row_mask:0xf bank_mask:0xf
    v_add_f32_dpp v18, v18, v18 row_ror:8 row_mask:0xf bank_mask:0xf
    v_add_f32_dpp v19, v19, v19 row_ror:8 row_mask:0xf bank_mask:0xf
    v_mov_b32 v24, v16
    v_mov_b32 v25, v17
    v_mov_b32 v26, v18
    v_mov_b32 v27, v19
    v_permlane16_swap_b32 v16, v24
    v_permlane16_swap_b32 v17, v25
    v_permlane16_swap_b32 v18, v26
    v_permlane16_swap_b32 v19, v27
    v_add_f32 v16, v16, v24
    v_add_f32 v17, v17, v25
    v_add_f32 v18, v18, v26
    v_add_f32 v19, v19, v27
    v_mov_b32 v24, v16
    v_mov_b32 v25, v17
    v_mov_b32 v26, v18
    v_mov_b32 v27, v19
    v_permlane32_swap_b32 v16, v24
    v_permlane32_swap_b32 v17, v25
    v_permlane32_swap_b32 v18, v26
    v_permlane32_swap_b32 v19, v27
    v_add_f32 v16, v16, v24
    v_add_f32 v17, v17, v25
    v_add_f32 v18, v18, v26
    v_add_f32 v19, v19, v27
    s_mov_b64 exec, 0xff
    ds_write_b128 v10, v[16:19] offset:0
    s_mov_b64 exec, -1
    s_waitcnt lgkmcnt(0)
    s_barrier
    s_cmp_eq_u32 s39, 0
    s_cbranch_scc0 L_fin
    ds_read_b32 v16, v30 offset:0
    ds_read_b32 v17, v30 offset:128
    ds_read_b32 v18, v30 offset:256
    ds_read_b32 v19, v30 offset:384
    ds_read_b32 v20, v30 offset:512
    ds_read_b32 v21, v30 offset:640
    ds_read_b32 v22, v30 offset:768
    ds_read_b32 v23, v30 offset:896
    s_lshl_b32 s3, s73, 4
    s_waitcnt lgkmcnt(0)
    v_add_f32 v16, v16, v17
    v_add_f32 v18, v18, v19
    v_add_f32 v20, v20, v21
    v_add_f32 v22, v22, v23
    v_add_f32 v16, v16, v18
    v_add_f32 v20, v20, v22
    v_add_f32 v16, v16, v20
    v_sub_f32 v16, v16, v61
    v_fma_f32 v16, v62, v16, v61
    v_cvt_pk_bf16_f32 v16, v16, v16
    s_mov_b64 exec, 0xffffffff
    buffer_store_short v16, v31, s[44:47], s3 offen
    s_mov_b64 exec, -1
    s_cmp_eq_u32 s73, 0
    s_cbranch_scc0 L_fin
    v_mov_b32 v13, 0
    v_mov_b32 v14, s38
    s_mov_b64 exec, 1
    buffer_store_dword v14, v13, s[4:7], 0 offen sc1
    s_mov_b64 exec, -1
L_fin:
    s_waitcnt vmcnt(0)
L_end:
    s_endpgm
.section .rodata,"a"
.p2align 6
.amdhsa_kernel gated_mix__compressed_kv_cla__mixer_token_mlp__decode_kernel
  .amdhsa_next_free_vgpr 256
  .amdhsa_next_free_sgpr 102
  .amdhsa_accum_offset 256
  .amdhsa_group_segment_fixed_size 0
  .amdhsa_kernarg_size 120
  .amdhsa_user_sgpr_count 2
  .amdhsa_user_sgpr_kernarg_segment_ptr 1
  .amdhsa_system_sgpr_workgroup_id_x 1
  .amdhsa_float_denorm_mode_32 3
.end_amdhsa_kernel
```
